```python
import torch

def _softmax(x, axis=-1):
    return torch.softmax(x, dim=axis)
def _gelu(x):
    return torch.nn.functional.gelu(x, approximate="tanh")
def _silu(x):
    return torch.nn.functional.silu(x)
def _sigmoid(x):
    return torch.sigmoid(x)
def _layernorm(x, axis=-1, eps=1e-5):
    m = x.mean(dim=axis, keepdim=True)
    v = x.var(dim=axis, keepdim=True, unbiased=False)
    return (x - m) / torch.sqrt(v + eps)
def _scatter_add(tgt, idx, src, axis=0):
    return tgt.clone().index_add_(axis, idx, src)
def _segment_sum(src, seg, n):
    out = torch.zeros((n,) + src.shape[1:], dtype=src.dtype)
    return out.index_add_(0, seg, src)
def _pad(x, pw):
    flat = tuple(v for pair in reversed(pw) for v in pair)
    return torch.nn.functional.pad(x, flat)

kernel_name = 'recurrent_scan__ssm_conv_h3__moe_arch_mod__prompt'

def setup_inputs():

    _w = (lambda a: (lambda t: t.to(torch.bfloat16) if t.is_floating_point() else t)(torch.as_tensor(a)))
    def _A_setup():
        B, S, D = 1, 2048, 640
        ks = 4
        return {
            "q": _w((lambda *s: torch.randn(*s, dtype=torch.bfloat16) * 0.1)(B, S, D)),
            "k": _w((lambda *s: torch.randn(*s, dtype=torch.bfloat16) * 1.6)(B, S, D)),
            "v": _w((lambda *s: torch.randn(*s, dtype=torch.bfloat16) * 1.6)(B, S, D)),
            "shift_k": _w((lambda *s: torch.randn(*s, dtype=torch.bfloat16) * 1.6)(D, ks) * 0.5),
            "ssm_k": _w((lambda *s: torch.randn(*s, dtype=torch.bfloat16) * 1.6)(D, S) * (1.0 / S ** 0.5)),
            "ssm_D": _w((lambda *s: torch.randn(*s, dtype=torch.bfloat16) * 1.6)(D)),
        }
    _A_in = _A_setup()

    def _B_setup():
        B, S, D, F, C = 1, 2048, 640, 1536, 8
        return {
            "x": _w((lambda *s: torch.randn(*s, dtype=torch.bfloat16) * 0.1)(B, S, D)),
            "w_r": _w((lambda *s: torch.randn(*s, dtype=torch.bfloat16) * 1.6)(D)),
            "w_gate": _w((lambda *s: torch.randn(*s, dtype=torch.bfloat16) * 1.6)(D, F)),
            "w_up": _w((lambda *s: torch.randn(*s, dtype=torch.bfloat16) * 1.6)(D, F)),
            "w_down": _w((lambda *s: torch.randn(*s, dtype=torch.bfloat16) * 1.6)(F, D)),
        }
    _B_in = _B_setup()

    return {
        "A_q": _A_in["q"],
        "A_k": _A_in["k"],
        "A_v": _A_in["v"],
        "A_shift_k": _A_in["shift_k"],
        "A_ssm_k": _A_in["ssm_k"],
        "A_ssm_D": _A_in["ssm_D"],
        "B_x": _B_in["x"],
        "B_w_r": _B_in["w_r"],
        "B_w_gate": _B_in["w_gate"],
        "B_w_up": _B_in["w_up"],
        "B_w_down": _B_in["w_down"],
    }

def reference(A_q, A_k, A_v, A_shift_k, A_ssm_k, A_ssm_D, B_x, B_w_r, B_w_gate, B_w_up, B_w_down):
    def _A_ref(q, k, v, shift_k, ssm_k, ssm_D):
        B, S, D = q.shape
        ks = shift_k.shape[-1]
        k_pad = _pad(k, ((0, 0), (ks - 1, 0), (0, 0)))
        k_shift = torch.zeros_like(k)
        for t in range(ks):
            k_shift = k_shift + k_pad[:, t:t + S, :] * shift_k[:, ks - 1 - t][None, None, :]
        kv = k_shift * v
        L = 2 * S
        kv_pad = _pad(kv, ((0, 0), (0, S), (0, 0)))
        kf_pad = _pad(ssm_k, ((0, 0), (0, S)))
        kv_f = (lambda x, axes=(-2,-1): torch.fft.rfft2(x.float(), dim=axes))(kv_pad[:, None, :, :], axes=(1, 2))
        kf_f = (lambda x, axes=(-2,-1): torch.fft.rfft2(x.float(), dim=axes))(kf_pad[:, None, :], axes=(1, 2))
        kf_f = (lambda x, *d: x.permute(*d))(kf_f, 1, 2, 0)
        y_f = kv_f * kf_f[None, :, :, :]
        y = (lambda x, s, axes=(-2,-1): torch.fft.irfft2(x, s=s, dim=axes).to(torch.bfloat16))(y_f, (1, L), axes=(1, 2))[:, 0, :S, :]
        y = y + kv * ssm_D[None, None, :]
        return q * y

    def _B_ref(x, w_r, w_gate, w_up, w_down):
        B, S, D = x.shape
        C = 8
        r = x @ w_r
        idx = torch.argsort(-r, axis=-1)[:, :C]
        idx_e = (lambda x, n, axis: torch.repeat_interleave(x, n, dim=axis))(idx.reshape(B, C, 1), D, axis=2)
        x_sel = (lambda x, i, axis: torch.take_along_dim(x, i, dim=axis))(x, idx_e, axis=1)
        g = _silu(x_sel @ w_gate)
        u = x_sel @ w_up
        y = (g * u) @ w_down
        r_sel = _sigmoid((lambda x, i, axis: torch.take_along_dim(x, i, dim=axis))(r, idx, axis=1))
        y = y * r_sel.reshape(B, C, 1)
        b_off = (torch.arange(B) * S).reshape(B, 1)
        flat_idx = (idx + b_off).reshape(B * C)
        zero = (x * 0.0).reshape(B * S, D)
        upd = _scatter_add(zero, flat_idx, y.reshape(B * C, D), axis=0)
        return x + upd.reshape(B, S, D)

    x = A_q
    xn = _layernorm(x, axis=-1)
    s = _A_ref(xn, A_k, A_v, A_shift_k, A_ssm_k, A_ssm_D)
    g = _silu(_B_ref(xn, B_w_r, B_w_gate, B_w_up, B_w_down))
    return x + s * g
```

```asm
; @launch grid=(256,1,1) block=(640,1,1) lds=103936
.amdgcn_target "amdgcn-amd-amdhsa--gfx950"
.text
.globl recurrent_scan__ssm_conv_h3__moe_arch_mod__prompt_kernel
.p2align 8
.type recurrent_scan__ssm_conv_h3__moe_arch_mod__prompt_kernel,@function
recurrent_scan__ssm_conv_h3__moe_arch_mod__prompt_kernel:
    s_cmp_ge_u32 s2, 256
    s_cbranch_scc1 L_end
    s_load_dwordx16 s[4:19], s[0:1], 0
    s_load_dwordx8 s[20:27], s[0:1], 64
    s_load_dwordx4 s[28:31], s[0:1], 96
    s_getpc_b64 s[82:83]
L_pc:
    v_lshlrev_b32 v2, 6, v0
    v_min_u32 v2, L_code_end-L_pc-4, v2
    global_load_dword v3, v2, s[82:83]
    v_lshrrev_b32 v4, 6, v0
    v_and_b32 v1, 63, v0
    v_subrev_u32 v0, 64, v0
    v_readfirstlane_b32 s3, v4
    v_lshlrev_b32 v5, 2, v0
    s_and_b32 s84, s2, 7
    s_lshr_b32 s85, s2, 3
    s_lshl_b32 s60, s84, 5
    s_add_u32 s60, s60, s85
    s_mul_i32 s86, s84, 20
    s_add_u32 s63, s86, s85
    s_mov_b32 s64, 1
    s_mul_i32 s86, s84, 6
    s_add_u32 s86, s86, s85
    s_sub_u32 s86, s86, 20
    s_cmp_ge_u32 s85, 20
    s_cselect_b32 s63, s86, s63
    s_cselect_b32 s64, 2, s64
    s_mul_i32 s86, s84, 5
    s_add_u32 s86, s86, s85
    s_sub_u32 s86, s86, 26
    s_cmp_ge_u32 s85, 26
    s_cselect_b32 s63, s86, s63
    s_cselect_b32 s64, 3, s64
    s_cmp_ge_u32 s85, 31
    s_cselect_b32 s64, 0, s64
    s_mul_i32 s87, s60, 10240
    s_add_u32 s88, s87, 5120
    s_sub_u32 s61, s3, 1
    v_mov_b32 v6, 9113600
    s_mov_b32 s86, 0xffff0000
    s_waitcnt lgkmcnt(0)
    s_mov_b32 s32, s4
    s_mov_b32 s33, s5
    s_mov_b32 s34, 2621440
    s_mov_b32 s35, 0x20000
    s_mov_b32 s48, s30
    s_mov_b32 s49, s31
    s_mov_b32 s50, 10485760
    s_mov_b32 s51, 0x20000
    s_mov_b32 s44, s26
    s_mov_b32 s45, s27
    s_mov_b32 s46, 2621440
    s_mov_b32 s47, 0x20000
    s_cmp_eq_u32 s3, 0
    s_cbranch_scc1 L_aux
    s_cmp_ge_u32 s3, 6
    s_cbranch_scc1 L_role
    s_mov_b32 s36, s6
    s_mov_b32 s37, s7
    s_mov_b32 s38, 2621440
    s_mov_b32 s39, 0x20000
    s_mov_b32 s40, s8
    s_mov_b32 s41, s9
    s_mov_b32 s42, 2621440
    s_mov_b32 s43, 0x20000
    s_sub_u32 s89, s87, 3840
    s_cmp_eq_u32 s60, 0
    s_cselect_b32 s89, 0, s89
    s_cselect_b32 s90, 0, -1
    buffer_load_dword v7, v6, s[48:51], 0 offen sc1
    global_load_dword v69, v5, s[18:19]
    buffer_load_dword v128, v5, s[32:35], s87 offen offset:0
    buffer_load_dword v129, v5, s[32:35], s87 offen offset:1280
    buffer_load_dword v130, v5, s[32:35], s87 offen offset:2560
    buffer_load_dword v131, v5, s[32:35], s87 offen offset:3840
    buffer_load_dword v132, v5, s[32:35], s88 offen offset:0
    buffer_load_dword v133, v5, s[32:35], s88 offen offset:1280
    buffer_load_dword v134, v5, s[32:35], s88 offen offset:2560
    buffer_load_dword v135, v5, s[32:35], s88 offen offset:3840
    v_lshlrev_b32 v6, 4, v0
    s_barrier
    global_load_dwordx4 v[70:73], v6, s[10:11]
    buffer_load_dword v50, v5, s[36:39], s89 offen offset:0
    buffer_load_dword v51, v5, s[36:39], s89 offen offset:1280
    buffer_load_dword v52, v5, s[36:39], s89 offen offset:2560
    buffer_load_dword v53, v5, s[36:39], s87 offen offset:0
    buffer_load_dword v54, v5, s[36:39], s87 offen offset:1280
    buffer_load_dword v55, v5, s[36:39], s87 offen offset:2560
    buffer_load_dword v56, v5, s[36:39], s87 offen offset:3840
    buffer_load_dword v57, v5, s[36:39], s88 offen offset:0
    buffer_load_dword v58, v5, s[36:39], s88 offen offset:1280
    buffer_load_dword v59, v5, s[36:39], s88 offen offset:2560
    buffer_load_dword v60, v5, s[36:39], s88 offen offset:3840
    buffer_load_dword v61, v5, s[40:43], s87 offen offset:0 nt
    buffer_load_dword v62, v5, s[40:43], s87 offen offset:1280 nt
    buffer_load_dword v63, v5, s[40:43], s87 offen offset:2560 nt
    buffer_load_dword v64, v5, s[40:43], s87 offen offset:3840 nt
    buffer_load_dword v65, v5, s[40:43], s88 offen offset:0 nt
    buffer_load_dword v66, v5, s[40:43], s88 offen offset:1280 nt
    buffer_load_dword v67, v5, s[40:43], s88 offen offset:2560 nt
    buffer_load_dword v68, v5, s[40:43], s88 offen offset:3840 nt
    v_lshrrev_b32 v8, 3, v1
    s_lshl_b32 s85, s61, 7
    v_lshl_add_u32 v8, v8, 4, s85
    s_mov_b32 s84, 0x3f803f80
    s_waitcnt vmcnt(28)
    v_dot2_f32_bf16 v98, v69, s84, 0
    v_readfirstlane_b32 s85, v7
    s_nop 0
    s_mul_i32 s85, s85, 0x41c64e6d
    s_add_u32 s62, s85, 0x3039
    v_mov_b32 v99, v98
    s_nop 1
    v_permlane32_swap_b32 v98, v99
    v_add_f32 v98, v98, v99
    v_mov_b32 v99, v98
    s_nop 1
    v_permlane16_swap_b32 v98, v99
    v_add_f32 v98, v98, v99
    s_nop 1
    v_add_f32_dpp v103, v98, v98 row_ror:8 row_mask:0xf bank_mask:0xf
    s_waitcnt vmcnt(20)
    v_dot2_f32_bf16 v74, v128, s84, 0
    v_dot2_f32_bf16 v82, v128, v128, 0
    v_dot2_f32_bf16 v90, v128, v69, 0
    v_dot2_f32_bf16 v75, v129, s84, 0
    v_dot2_f32_bf16 v83, v129, v129, 0
    v_dot2_f32_bf16 v91, v129, v69, 0
    v_dot2_f32_bf16 v76, v130, s84, 0
    v_dot2_f32_bf16 v84, v130, v130, 0
    v_dot2_f32_bf16 v92, v130, v69, 0
    v_dot2_f32_bf16 v77, v131, s84, 0
    v_dot2_f32_bf16 v85, v131, v131, 0
    v_dot2_f32_bf16 v93, v131, v69, 0
    v_dot2_f32_bf16 v78, v132, s84, 0
    v_dot2_f32_bf16 v86, v132, v132, 0
    v_dot2_f32_bf16 v94, v132, v69, 0
    v_dot2_f32_bf16 v79, v133, s84, 0
    v_dot2_f32_bf16 v87, v133, v133, 0
    v_dot2_f32_bf16 v95, v133, v69, 0
    v_dot2_f32_bf16 v80, v134, s84, 0
    v_dot2_f32_bf16 v88, v134, v134, 0
    v_dot2_f32_bf16 v96, v134, v69, 0
    v_dot2_f32_bf16 v81, v135, s84, 0
    v_dot2_f32_bf16 v89, v135, v135, 0
    v_dot2_f32_bf16 v97, v135, v69, 0
    v_permlane32_swap_b32 v74, v78
    v_permlane32_swap_b32 v82, v86
    v_permlane32_swap_b32 v90, v94
    v_permlane32_swap_b32 v75, v79
    v_permlane32_swap_b32 v83, v87
    v_permlane32_swap_b32 v91, v95
    v_permlane32_swap_b32 v76, v80
    v_permlane32_swap_b32 v84, v88
    v_permlane32_swap_b32 v92, v96
    v_permlane32_swap_b32 v77, v81
    v_permlane32_swap_b32 v85, v89
    v_permlane32_swap_b32 v93, v97
    v_add_f32 v74, v74, v78
    v_add_f32 v82, v82, v86
    v_add_f32 v90, v90, v94
    v_add_f32 v75, v75, v79
    v_add_f32 v83, v83, v87
    v_add_f32 v91, v91, v95
    v_add_f32 v76, v76, v80
    v_add_f32 v84, v84, v88
    v_add_f32 v92, v92, v96
    v_add_f32 v77, v77, v81
    v_add_f32 v85, v85, v89
    v_add_f32 v93, v93, v97
    v_permlane16_swap_b32 v74, v76
    v_permlane16_swap_b32 v82, v84
    v_permlane16_swap_b32 v90, v92
    v_permlane16_swap_b32 v75, v77
    v_permlane16_swap_b32 v83, v85
    v_permlane16_swap_b32 v91, v93
    v_add_f32 v74, v74, v76
    v_add_f32 v82, v82, v84
    v_add_f32 v90, v90, v92
    v_add_f32 v75, v75, v77
    v_add_f32 v83, v83, v85
    v_add_f32 v91, v91, v93
    v_add_f32_dpp v100, v74, v74 row_ror:8 row_mask:0xf bank_mask:0x3
    v_add_f32_dpp v101, v82, v82 row_ror:8 row_mask:0xf bank_mask:0x3
    v_add_f32_dpp v102, v90, v90 row_ror:8 row_mask:0xf bank_mask:0x3
    v_add_f32_dpp v100, v75, v75 row_ror:8 row_mask:0xf bank_mask:0xc
    v_add_f32_dpp v101, v83, v83 row_ror:8 row_mask:0xf bank_mask:0xc
    v_add_f32_dpp v102, v91, v91 row_ror:8 row_mask:0xf bank_mask:0xc
    v_add_f32_dpp v103, v103, v103 row_half_mirror row_mask:0xf bank_mask:0xf
    v_add_f32_dpp v100, v100, v100 row_half_mirror row_mask:0xf bank_mask:0xf
    v_add_f32_dpp v101, v101, v101 row_half_mirror row_mask:0xf bank_mask:0xf
    v_add_f32_dpp v102, v102, v102 row_half_mirror row_mask:0xf bank_mask:0xf
    v_add_f32_dpp v103, v103, v103 quad_perm:[1,0,3,2] row_mask:0xf bank_mask:0xf
    v_add_f32_dpp v100, v100, v100 quad_perm:[1,0,3,2] row_mask:0xf bank_mask:0xf
    v_add_f32_dpp v101, v101, v101 quad_perm:[1,0,3,2] row_mask:0xf bank_mask:0xf
    v_add_f32_dpp v102, v102, v102 quad_perm:[1,0,3,2] row_mask:0xf bank_mask:0xf
    v_add_f32_dpp v103, v103, v103 quad_perm:[2,3,0,1] row_mask:0xf bank_mask:0xf
    v_add_f32_dpp v100, v100, v100 quad_perm:[2,3,0,1] row_mask:0xf bank_mask:0xf
    v_add_f32_dpp v101, v101, v101 quad_perm:[2,3,0,1] row_mask:0xf bank_mask:0xf
    v_add_f32_dpp v102, v102, v102 quad_perm:[2,3,0,1] row_mask:0xf bank_mask:0xf
    s_mov_b32 s92, 0x01010101
    s_mov_b32 exec_lo, s92
    s_mov_b32 exec_hi, s92
    ds_write_b128 v8, v[100:103] offset:640
    s_mov_b64 exec, -1
    v_lshrrev_b32 v4, 3, v0
    v_mul_u32_u24 v4, 98304, v4
    v_and_b32 v6, 7, v0
    v_lshl_add_u32 v4, v6, 4, v4
    s_lshl_b32 s84, s60, 7
    s_add_u32 s91, s84, 32768
    s_add_u32 s89, s84, 65536
    s_waitcnt lgkmcnt(0)
    s_barrier
    s_waitcnt vmcnt(19)
    v_lshlrev_b32 v96, 16, v70
    v_lshlrev_b32 v97, 16, v72
    v_and_b32 v98, s86, v70
    v_and_b32 v99, s86, v72
    v_lshlrev_b32 v100, 16, v71
    v_lshlrev_b32 v101, 16, v73
    v_and_b32 v102, s86, v71
    v_and_b32 v103, s86, v73
    s_waitcnt vmcnt(8)
    v_and_b32 v50, s90, v50
    v_and_b32 v51, s90, v51
    v_and_b32 v52, s90, v52
    v_lshlrev_b32 v74, 16, v50
    v_and_b32 v75, s86, v50
    v_lshlrev_b32 v76, 16, v51
    v_and_b32 v77, s86, v51
    v_lshlrev_b32 v78, 16, v52
    v_and_b32 v79, s86, v52
    v_lshlrev_b32 v80, 16, v53
    v_and_b32 v81, s86, v53
    v_lshlrev_b32 v82, 16, v54
    v_and_b32 v83, s86, v54
    v_lshlrev_b32 v84, 16, v55
    v_and_b32 v85, s86, v55
    v_lshlrev_b32 v86, 16, v56
    v_and_b32 v87, s86, v56
    v_lshlrev_b32 v88, 16, v57
    v_and_b32 v89, s86, v57
    v_lshlrev_b32 v90, 16, v58
    v_and_b32 v91, s86, v58
    v_lshlrev_b32 v92, 16, v59
    v_and_b32 v93, s86, v59
    v_lshlrev_b32 v94, 16, v60
    v_and_b32 v95, s86, v60
    v_pk_mul_f32 v[104:105], v[74:75], v[102:103]
    v_pk_mul_f32 v[106:107], v[76:77], v[102:103]
    v_pk_mul_f32 v[108:109], v[78:79], v[102:103]
    v_pk_mul_f32 v[110:111], v[80:81], v[102:103]
    v_pk_mul_f32 v[112:113], v[82:83], v[102:103]
    v_pk_mul_f32 v[114:115], v[84:85], v[102:103]
    v_pk_mul_f32 v[116:117], v[86:87], v[102:103]
    v_pk_mul_f32 v[118:119], v[88:89], v[102:103]
    v_pk_fma_f32 v[104:105], v[76:77], v[100:101], v[104:105]
    v_pk_fma_f32 v[106:107], v[78:79], v[100:101], v[106:107]
    v_pk_fma_f32 v[108:109], v[80:81], v[100:101], v[108:109]
    v_pk_fma_f32 v[110:111], v[82:83], v[100:101], v[110:111]
    v_pk_fma_f32 v[112:113], v[84:85], v[100:101], v[112:113]
    v_pk_fma_f32 v[114:115], v[86:87], v[100:101], v[114:115]
    v_pk_fma_f32 v[116:117], v[88:89], v[100:101], v[116:117]
    v_pk_fma_f32 v[118:119], v[90:91], v[100:101], v[118:119]
    v_pk_fma_f32 v[104:105], v[78:79], v[98:99], v[104:105]
    v_pk_fma_f32 v[106:107], v[80:81], v[98:99], v[106:107]
    v_pk_fma_f32 v[108:109], v[82:83], v[98:99], v[108:109]
    v_pk_fma_f32 v[110:111], v[84:85], v[98:99], v[110:111]
    v_pk_fma_f32 v[112:113], v[86:87], v[98:99], v[112:113]
    v_pk_fma_f32 v[114:115], v[88:89], v[98:99], v[114:115]
    v_pk_fma_f32 v[116:117], v[90:91], v[98:99], v[116:117]
    v_pk_fma_f32 v[118:119], v[92:93], v[98:99], v[118:119]
    v_pk_fma_f32 v[104:105], v[80:81], v[96:97], v[104:105]
    v_pk_fma_f32 v[106:107], v[82:83], v[96:97], v[106:107]
    v_pk_fma_f32 v[108:109], v[84:85], v[96:97], v[108:109]
    v_pk_fma_f32 v[110:111], v[86:87], v[96:97], v[110:111]
    v_pk_fma_f32 v[112:113], v[88:89], v[96:97], v[112:113]
    v_pk_fma_f32 v[114:115], v[90:91], v[96:97], v[114:115]
    v_pk_fma_f32 v[116:117], v[92:93], v[96:97], v[116:117]
    v_pk_fma_f32 v[118:119], v[94:95], v[96:97], v[118:119]
    v_mov_b32 v45, s62
    v_mov_b32 v49, s62
    v_mov_b32 v51, s62
    v_mov_b32 v53, s62
    s_waitcnt vmcnt(0)
    v_lshlrev_b32 v120, 16, v61
    v_and_b32 v121, s86, v61
    v_pk_mul_f32 v[104:105], v[104:105], v[120:121]
    v_lshlrev_b32 v122, 16, v62
    v_and_b32 v123, s86, v62
    v_pk_mul_f32 v[106:107], v[106:107], v[122:123]
    v_lshlrev_b32 v124, 16, v63
    v_and_b32 v125, s86, v63
    v_pk_mul_f32 v[108:109], v[108:109], v[124:125]
    v_lshlrev_b32 v126, 16, v64
    v_and_b32 v127, s86, v64
    v_pk_mul_f32 v[110:111], v[110:111], v[126:127]
    v_lshlrev_b32 v120, 16, v65
    v_and_b32 v121, s86, v65
    v_pk_mul_f32 v[112:113], v[112:113], v[120:121]
    v_lshlrev_b32 v122, 16, v66
    v_and_b32 v123, s86, v66
    v_pk_mul_f32 v[114:115], v[114:115], v[122:123]
    v_lshlrev_b32 v124, 16, v67
    v_and_b32 v125, s86, v67
    v_pk_mul_f32 v[116:117], v[116:117], v[124:125]
    v_lshlrev_b32 v126, 16, v68
    v_and_b32 v127, s86, v68
    v_pk_mul_f32 v[118:119], v[118:119], v[126:127]
    v_cvt_pk_bf16_f32 v42, v118, v116
    v_cvt_pk_bf16_f32 v43, v114, v112
    v_cvt_pk_bf16_f32 v44, v110, v108
    v_cvt_pk_bf16_f32 v50, v106, v104
    v_cvt_pk_bf16_f32 v46, v119, v117
    v_cvt_pk_bf16_f32 v47, v115, v113
    v_cvt_pk_bf16_f32 v48, v111, v109
    v_cvt_pk_bf16_f32 v52, v107, v105
    buffer_store_dwordx4 v[42:45], v4, s[48:51], s84 offen sc1
    buffer_store_dwordx4 v[46:49], v4, s[48:51], s91 offen sc1
    buffer_store_dwordx4 v[50:53], v4, s[48:51], s89 offen sc1
    v_and_b32 v6, 7, v1
    v_lshlrev_b32 v6, 4, v6
    s_barrier
    ds_read_b64 v[136:137], v6 offset:0
    s_cmp_lg_u32 s61, 4
    s_cbranch_scc1 L_notouch
    s_cmp_eq_u32 s64, 0
    s_cbranch_scc1 L_notouch
    s_and_b32 s84, s2, 7
    s_lshr_b32 s85, s2, 3
    s_mov_b32 s58, 1966080
    s_mov_b32 s59, 0x20000
    s_cmp_ge_u32 s85, 16
    s_cselect_b32 s56, s22, s20
    s_cselect_b32 s57, s23, s21
    s_and_b32 s85, s85, 15
    s_mul_i32 s85, s85, 122880
    s_mul_i32 s91, s84, 384
    s_add_u32 s91, s91, s85
    s_add_u32 s90, s91, 61440
    v_min_u32 v4, 59, v1
    v_mul_u32_u24 v6, 21846, v4
    v_lshrrev_b32 v6, 16, v6
    v_mul_u32_u24 v8, 3, v6
    v_sub_u32 v4, v4, v8
    v_mul_u32_u24 v6, 3072, v6
    v_lshl_add_u32 v4, v4, 7, v6
    buffer_load_dword v166, v4, s[56:59], s91 offen
    buffer_load_dword v166, v4, s[56:59], s90 offen
L_notouch:
    s_waitcnt lgkmcnt(0)
    s_cmp_lg_u32 s64, 0
    s_cbranch_scc1 L_gate
    v_and_b32 v8, 15, v1
    v_lshlrev_b32 v8, 2, v8
    s_waitcnt lgkmcnt(0)
    s_barrier
    ds_read_b32 v60, v8 offset:576
    v_mov_b32 v6, 208
    v_mov_b32 v43, 1
    s_waitcnt lgkmcnt(0)
L_sel_rank_3:
    s_waitcnt lgkmcnt(0)
    s_barrier
    ds_read_b32 v62, v6
    ds_read_b32 v60, v8 offset:128
    s_waitcnt lgkmcnt(0)
    v_readfirstlane_b32 s84, v62
    s_nop 0
    s_cmp_le_u32 s84, 16
    s_cbranch_scc1 L_sel_done_6
    s_barrier
    v_lshlrev_b32 v4, 2, v1
    v_min_u32 v4, 80, v4
    v_mov_b32 v6, 0
    ds_write_b32 v4, v6 offset:128
    v_mov_b32 v6, 208
    s_waitcnt lgkmcnt(0)
    s_barrier
    s_branch L_sel_rank_3
L_sel_done_6:
    v_mov_b32 v62, 0
    v_sub_co_u32_dpp v63, vcc, v60, v60 row_ror:1 row_mask:0xf bank_mask:0xf
    v_addc_co_u32 v62, vcc, 0, v62, vcc
    s_nop 0
    v_sub_co_u32_dpp v63, vcc, v60, v60 row_ror:2 row_mask:0xf bank_mask:0xf
    v_addc_co_u32 v62, vcc, 0, v62, vcc
    s_nop 0
    v_sub_co_u32_dpp v63, vcc, v60, v60 row_ror:3 row_mask:0xf bank_mask:0xf
    v_addc_co_u32 v62, vcc, 0, v62, vcc
    s_nop 0
    v_sub_co_u32_dpp v63, vcc, v60, v60 row_ror:4 row_mask:0xf bank_mask:0xf
    v_addc_co_u32 v62, vcc, 0, v62, vcc
    s_nop 0
    v_sub_co_u32_dpp v63, vcc, v60, v60 row_ror:5 row_mask:0xf bank_mask:0xf
    v_addc_co_u32 v62, vcc, 0, v62, vcc
    s_nop 0
    v_sub_co_u32_dpp v63, vcc, v60, v60 row_ror:6 row_mask:0xf bank_mask:0xf
    v_addc_co_u32 v62, vcc, 0, v62, vcc
    s_nop 0
    v_sub_co_u32_dpp v63, vcc, v60, v60 row_ror:7 row_mask:0xf bank_mask:0xf
    v_addc_co_u32 v62, vcc, 0, v62, vcc
    s_nop 0
    v_sub_co_u32_dpp v63, vcc, v60, v60 row_ror:8 row_mask:0xf bank_mask:0xf
    v_addc_co_u32 v62, vcc, 0, v62, vcc
    s_nop 0
    v_sub_co_u32_dpp v63, vcc, v60, v60 row_ror:9 row_mask:0xf bank_mask:0xf
    v_addc_co_u32 v62, vcc, 0, v62, vcc
    s_nop 0
    v_sub_co_u32_dpp v63, vcc, v60, v60 row_ror:10 row_mask:0xf bank_mask:0xf
    v_addc_co_u32 v62, vcc, 0, v62, vcc
    s_nop 0
    v_sub_co_u32_dpp v63, vcc, v60, v60 row_ror:11 row_mask:0xf bank_mask:0xf
    v_addc_co_u32 v62, vcc, 0, v62, vcc
    s_nop 0
    v_sub_co_u32_dpp v63, vcc, v60, v60 row_ror:12 row_mask:0xf bank_mask:0xf
    v_addc_co_u32 v62, vcc, 0, v62, vcc
    s_nop 0
    v_sub_co_u32_dpp v63, vcc, v60, v60 row_ror:13 row_mask:0xf bank_mask:0xf
    v_addc_co_u32 v62, vcc, 0, v62, vcc
    s_nop 0
    v_sub_co_u32_dpp v63, vcc, v60, v60 row_ror:14 row_mask:0xf bank_mask:0xf
    v_addc_co_u32 v62, vcc, 0, v62, vcc
    s_nop 0
    v_sub_co_u32_dpp v63, vcc, v60, v60 row_ror:15 row_mask:0xf bank_mask:0xf
    v_addc_co_u32 v62, vcc, 0, v62, vcc
    v_and_b32 v4, 2047, v60
    v_sub_u32 v44, 2047, v4
    v_cmp_lt_u32 s[90:91], 7, v62
    v_lshrrev_b32 v4, 3, v44
    v_and_b32 v6, 7, v44
    v_lshlrev_b32 v6, v6, 1
    v_cmp_eq_u32 vcc, s60, v4
    s_nop 0
    s_and_b64 vcc, vcc, s[90:91]
    v_cndmask_b32 v6, 0, v6, vcc
    s_nop 1
    v_or_b32_dpp v6, v6, v6 row_ror:8 row_mask:0xf bank_mask:0xf
    s_nop 1
    v_or_b32_dpp v6, v6, v6 row_half_mirror row_mask:0xf bank_mask:0xf
    s_nop 1
    v_or_b32_dpp v6, v6, v6 quad_perm:[1,0,3,2] row_mask:0xf bank_mask:0xf
    s_nop 1
    v_or_b32_dpp v6, v6, v6 quad_perm:[2,3,0,1] row_mask:0xf bank_mask:0xf
    s_nop 0
    v_readfirstlane_b32 s65, v6
L_gate:
    v_readlane_b32 s66, v136, 0
    v_readlane_b32 s67, v137, 0
    v_readlane_b32 s68, v136, 1
    v_readlane_b32 s69, v137, 1
    v_readlane_b32 s70, v136, 2
    v_readlane_b32 s71, v137, 2
    v_readlane_b32 s72, v136, 3
    v_readlane_b32 s73, v137, 3
    v_readlane_b32 s74, v136, 4
    v_readlane_b32 s75, v137, 4
    v_readlane_b32 s76, v136, 5
    v_readlane_b32 s77, v137, 5
    v_readlane_b32 s78, v136, 6
    v_readlane_b32 s79, v137, 6
    v_readlane_b32 s80, v136, 7
    v_readlane_b32 s81, v137, 7
    s_mov_b32 s84, 0xbfb8aa3b
    v_lshlrev_b32 v10, 16, v128
    v_and_b32 v11, s86, v128
    v_lshlrev_b32 v12, 16, v129
    v_and_b32 v13, s86, v129
    v_lshlrev_b32 v14, 16, v130
    v_and_b32 v15, s86, v130
    v_lshlrev_b32 v16, 16, v131
    v_and_b32 v17, s86, v131
    v_lshlrev_b32 v18, 16, v132
    v_and_b32 v19, s86, v132
    v_lshlrev_b32 v20, 16, v133
    v_and_b32 v21, s86, v133
    v_lshlrev_b32 v22, 16, v134
    v_and_b32 v23, s86, v134
    v_lshlrev_b32 v24, 16, v135
    v_and_b32 v25, s86, v135
    v_pk_add_f32 v[140:141], v[10:11], s[66:67] op_sel_hi:[1,0] neg_lo:[0,1] neg_hi:[0,1]
    v_pk_add_f32 v[146:147], v[12:13], s[68:69] op_sel_hi:[1,0] neg_lo:[0,1] neg_hi:[0,1]
    v_pk_add_f32 v[152:153], v[14:15], s[70:71] op_sel_hi:[1,0] neg_lo:[0,1] neg_hi:[0,1]
    v_pk_add_f32 v[158:159], v[16:17], s[72:73] op_sel_hi:[1,0] neg_lo:[0,1] neg_hi:[0,1]
    v_cvt_pk_bf16_f32 v142, v140, v141
    v_cvt_pk_bf16_f32 v148, v146, v147
    v_cvt_pk_bf16_f32 v154, v152, v153
    v_cvt_pk_bf16_f32 v160, v158, v159
    v_lshlrev_b32 v140, 16, v142
    v_and_b32 v141, s86, v142
    v_lshlrev_b32 v146, 16, v148
    v_and_b32 v147, s86, v148
    v_lshlrev_b32 v152, 16, v154
    v_and_b32 v153, s86, v154
    v_lshlrev_b32 v158, 16, v160
    v_and_b32 v159, s86, v160
    v_pk_mul_f32 v[140:141], v[140:141], s[66:67] op_sel:[0,1] op_sel_hi:[1,1]
    v_pk_mul_f32 v[146:147], v[146:147], s[68:69] op_sel:[0,1] op_sel_hi:[1,1]
    v_pk_mul_f32 v[152:153], v[152:153], s[70:71] op_sel:[0,1] op_sel_hi:[1,1]
    v_pk_mul_f32 v[158:159], v[158:159], s[72:73] op_sel:[0,1] op_sel_hi:[1,1]
    v_cvt_pk_bf16_f32 v142, v140, v141
    v_cvt_pk_bf16_f32 v148, v146, v147
    v_cvt_pk_bf16_f32 v154, v152, v153
    v_cvt_pk_bf16_f32 v160, v158, v159
    v_lshlrev_b32 v140, 16, v142
    v_and_b32 v141, s86, v142
    v_lshlrev_b32 v146, 16, v148
    v_and_b32 v147, s86, v148
    v_lshlrev_b32 v152, 16, v154
    v_and_b32 v153, s86, v154
    v_lshlrev_b32 v158, 16, v160
    v_and_b32 v159, s86, v160
    v_pk_mul_f32 v[142:143], v[140:141], s[84:85] op_sel_hi:[1,0]
    v_pk_mul_f32 v[148:149], v[146:147], s[84:85] op_sel_hi:[1,0]
    v_pk_mul_f32 v[154:155], v[152:153], s[84:85] op_sel_hi:[1,0]
    v_pk_mul_f32 v[160:161], v[158:159], s[84:85] op_sel_hi:[1,0]
    v_exp_f32 v142, v142
    v_exp_f32 v143, v143
    v_exp_f32 v148, v148
    v_exp_f32 v149, v149
    v_exp_f32 v154, v154
    v_exp_f32 v155, v155
    v_exp_f32 v160, v160
    v_exp_f32 v161, v161
    v_pk_add_f32 v[142:143], v[142:143], 1.0 op_sel_hi:[1,0]
    v_pk_add_f32 v[148:149], v[148:149], 1.0 op_sel_hi:[1,0]
    v_pk_add_f32 v[154:155], v[154:155], 1.0 op_sel_hi:[1,0]
    v_pk_add_f32 v[160:161], v[160:161], 1.0 op_sel_hi:[1,0]
    v_rcp_f32 v142, v142
    v_rcp_f32 v143, v143
    v_rcp_f32 v148, v148
    v_rcp_f32 v149, v149
    v_rcp_f32 v154, v154
    v_rcp_f32 v155, v155
    v_rcp_f32 v160, v160
    v_rcp_f32 v161, v161
    v_pk_mul_f32 v[142:143], v[142:143], v[140:141]
    v_pk_mul_f32 v[148:149], v[148:149], v[146:147]
    v_pk_mul_f32 v[154:155], v[154:155], v[152:153]
    v_pk_mul_f32 v[160:161], v[160:161], v[158:159]
    v_cvt_pk_bf16_f32 v144, v142, v143
    v_cvt_pk_bf16_f32 v150, v148, v149
    v_cvt_pk_bf16_f32 v156, v154, v155
    v_cvt_pk_bf16_f32 v162, v160, v161
    v_lshlrev_b32 v142, 16, v144
    v_and_b32 v143, s86, v144
    v_lshlrev_b32 v148, 16, v150
    v_and_b32 v149, s86, v150
    v_lshlrev_b32 v154, 16, v156
    v_and_b32 v155, s86, v156
    v_lshlrev_b32 v160, 16, v162
    v_and_b32 v161, s86, v162
    v_pk_mul_f32 v[26:27], v[140:141], v[142:143]
    v_pk_mul_f32 v[28:29], v[146:147], v[148:149]
    v_pk_mul_f32 v[30:31], v[152:153], v[154:155]
    v_pk_mul_f32 v[32:33], v[158:159], v[160:161]
    v_pk_add_f32 v[140:141], v[18:19], s[74:75] op_sel_hi:[1,0] neg_lo:[0,1] neg_hi:[0,1]
    v_pk_add_f32 v[146:147], v[20:21], s[76:77] op_sel_hi:[1,0] neg_lo:[0,1] neg_hi:[0,1]
    v_pk_add_f32 v[152:153], v[22:23], s[78:79] op_sel_hi:[1,0] neg_lo:[0,1] neg_hi:[0,1]
    v_pk_add_f32 v[158:159], v[24:25], s[80:81] op_sel_hi:[1,0] neg_lo:[0,1] neg_hi:[0,1]
    v_cvt_pk_bf16_f32 v142, v140, v141
    v_cvt_pk_bf16_f32 v148, v146, v147
    v_cvt_pk_bf16_f32 v154, v152, v153
    v_cvt_pk_bf16_f32 v160, v158, v159
    v_lshlrev_b32 v140, 16, v142
    v_and_b32 v141, s86, v142
    v_lshlrev_b32 v146, 16, v148
    v_and_b32 v147, s86, v148
    v_lshlrev_b32 v152, 16, v154
    v_and_b32 v153, s86, v154
    v_lshlrev_b32 v158, 16, v160
    v_and_b32 v159, s86, v160
    v_pk_mul_f32 v[140:141], v[140:141], s[74:75] op_sel:[0,1] op_sel_hi:[1,1]
    v_pk_mul_f32 v[146:147], v[146:147], s[76:77] op_sel:[0,1] op_sel_hi:[1,1]
    v_pk_mul_f32 v[152:153], v[152:153], s[78:79] op_sel:[0,1] op_sel_hi:[1,1]
    v_pk_mul_f32 v[158:159], v[158:159], s[80:81] op_sel:[0,1] op_sel_hi:[1,1]
    v_cvt_pk_bf16_f32 v142, v140, v141
    v_cvt_pk_bf16_f32 v148, v146, v147
    v_cvt_pk_bf16_f32 v154, v152, v153
    v_cvt_pk_bf16_f32 v160, v158, v159
    v_lshlrev_b32 v140, 16, v142
    v_and_b32 v141, s86, v142
    v_lshlrev_b32 v146, 16, v148
    v_and_b32 v147, s86, v148
    v_lshlrev_b32 v152, 16, v154
    v_and_b32 v153, s86, v154
    v_lshlrev_b32 v158, 16, v160
    v_and_b32 v159, s86, v160
    v_pk_mul_f32 v[142:143], v[140:141], s[84:85] op_sel_hi:[1,0]
    v_pk_mul_f32 v[148:149], v[146:147], s[84:85] op_sel_hi:[1,0]
    v_pk_mul_f32 v[154:155], v[152:153], s[84:85] op_sel_hi:[1,0]
    v_pk_mul_f32 v[160:161], v[158:159], s[84:85] op_sel_hi:[1,0]
    v_exp_f32 v142, v142
    v_exp_f32 v143, v143
    v_exp_f32 v148, v148
    v_exp_f32 v149, v149
    v_exp_f32 v154, v154
    v_exp_f32 v155, v155
    v_exp_f32 v160, v160
    v_exp_f32 v161, v161
    v_pk_add_f32 v[142:143], v[142:143], 1.0 op_sel_hi:[1,0]
    v_pk_add_f32 v[148:149], v[148:149], 1.0 op_sel_hi:[1,0]
    v_pk_add_f32 v[154:155], v[154:155], 1.0 op_sel_hi:[1,0]
    v_pk_add_f32 v[160:161], v[160:161], 1.0 op_sel_hi:[1,0]
    v_rcp_f32 v142, v142
    v_rcp_f32 v143, v143
    v_rcp_f32 v148, v148
    v_rcp_f32 v149, v149
    v_rcp_f32 v154, v154
    v_rcp_f32 v155, v155
    v_rcp_f32 v160, v160
    v_rcp_f32 v161, v161
    v_pk_mul_f32 v[142:143], v[142:143], v[140:141]
    v_pk_mul_f32 v[148:149], v[148:149], v[146:147]
    v_pk_mul_f32 v[154:155], v[154:155], v[152:153]
    v_pk_mul_f32 v[160:161], v[160:161], v[158:159]
    v_cvt_pk_bf16_f32 v144, v142, v143
    v_cvt_pk_bf16_f32 v150, v148, v149
    v_cvt_pk_bf16_f32 v156, v154, v155
    v_cvt_pk_bf16_f32 v162, v160, v161
    v_lshlrev_b32 v142, 16, v144
    v_and_b32 v143, s86, v144
    v_lshlrev_b32 v148, 16, v150
    v_and_b32 v149, s86, v150
    v_lshlrev_b32 v154, 16, v156
    v_and_b32 v155, s86, v156
    v_lshlrev_b32 v160, 16, v162
    v_and_b32 v161, s86, v162
    v_pk_mul_f32 v[34:35], v[140:141], v[142:143]
    v_pk_mul_f32 v[36:37], v[146:147], v[148:149]
    v_pk_mul_f32 v[38:39], v[152:153], v[154:155]
    v_pk_mul_f32 v[40:41], v[158:159], v[160:161]
    s_cmp_lg_u32 s64, 1
    s_cbranch_scc1 L_po
    v_and_b32 v44, 3, v0
    v_lshrrev_b32 v45, 2, v0
    v_add_u32 v45, 0, v45
    v_mul_u32_u24 v47, 4160, v44
    v_lshrrev_b32 v46, 5, v45
    v_lshl_add_u32 v47, v46, 9, v47
    v_and_b32 v46, 1, v45
    v_lshl_add_u32 v47, v46, 8, v47
    v_bfe_u32 v46, v45, 1, 4
    v_lshl_add_u32 v47, v46, 4, v47
    v_lshrrev_b32 v7, 2, v45
    v_mul_u32_u24 v7, 20480, v7
    v_and_b32 v44, 15, v0
    v_lshl_add_u32 v7, v44, 3, v7
    v_lshrrev_b32 v3, 1, v45
    v_mul_u32_u24 v3, 20480, v3
    v_and_b32 v44, 7, v0
    v_lshl_add_u32 v3, v44, 4, v3
    v_add_u32 v2, 87296, v47
    s_lshl_b32 s93, s63, 7
    s_add_u32 s92, s93, 4194304
    s_add_u32 s93, s93, 7340032
    s_barrier
    s_barrier
    s_cmp_eq_u32 s61, 4
    s_cbranch_scc1 L_pc_w4_7
    ds_read_b128 v[64:67], v2 offset:0
    ds_read_b128 v[68:71], v2 offset:1024
    ds_read_b128 v[72:75], v2 offset:2048
    v_mov_b32 v45, s62
    v_mov_b32 v47, s62
    v_mov_b32 v49, s62
    s_waitcnt lgkmcnt(2)
    v_mov_b32 v44, v67
    v_mov_b32 v67, s62
    buffer_store_dwordx4 v[64:67], v3, s[48:51], s92 offen sc1
    buffer_store_dwordx2 v[44:45], v7, s[48:51], s93 offen sc1
    s_add_u32 s92, s92, 655360
    s_add_u32 s93, s93, 327680
    s_waitcnt lgkmcnt(1)
    v_mov_b32 v46, v71
    v_mov_b32 v71, s62
    buffer_store_dwordx4 v[68:71], v3, s[48:51], s92 offen sc1
    buffer_store_dwordx2 v[46:47], v7, s[48:51], s93 offen sc1
    s_add_u32 s92, s92, 655360
    s_add_u32 s93, s93, 327680
    s_waitcnt lgkmcnt(0)
    v_mov_b32 v48, v75
    v_mov_b32 v75, s62
    buffer_store_dwordx4 v[72:75], v3, s[48:51], s92 offen sc1
    buffer_store_dwordx2 v[48:49], v7, s[48:51], s93 offen sc1
L_pc_w4_7:
    s_barrier
    v_mov_b32 v4, 256
    ds_read_b32 v6, v4
    s_waitcnt lgkmcnt(0)
    v_readfirstlane_b32 s65, v6
    s_cmp_lt_u32 s60, 192
    s_cbranch_scc1 L_pc_w4_7_e
    s_barrier
L_pc_w4_7_e:
    s_branch L_p3
L_po:
    s_cmp_eq_u32 s64, 0
    s_cbranch_scc1 L_po_n3_9
    s_cmp_lg_u32 s64, 2
    s_cbranch_scc1 L_po_n2_8
    s_waitcnt vmcnt(0)
    s_barrier
L_po_n2_8:
    s_barrier
    s_barrier
    v_mov_b32 v4, 256
    ds_read_b32 v6, v4
    s_waitcnt lgkmcnt(0)
    v_readfirstlane_b32 s65, v6
    s_cmp_eq_u32 s64, 3
    s_cbranch_scc1 L_p3
L_po_n3_9:
    v_and_b32 v4, 7, v1
    v_mul_u32_u24 v4, 2560, v4
    s_sub_u32 s84, s60, 64
    s_cmp_ge_u32 s60, 192
    s_cselect_b32 s84, s84, s60
    s_lshr_b32 s84, s84, 1
    s_mul_i32 s84, s84, 20480
    s_add_u32 s84, s84, 4196736
    s_and_b32 s85, s60, 1
    s_lshl_b32 s85, s85, 6
    s_add_u32 s84, s84, s85
    s_mov_b32 s95, 0
    s_mul_i32 s83, s62, 1
L_poll_10:
    buffer_load_dword v44, v4, s[48:51], s84 offen offset:12 sc1
L_chk_12:
    s_waitcnt vmcnt(0)
    v_cmp_ne_u32 vcc, s83, v44
    s_add_u32 s95, s95, 1
    s_and_b64 exec, vcc, vcc
    s_cbranch_execz L_polled_11
    s_sleep 2
    s_cmp_lt_u32 s95, 400000
    s_cbranch_scc1 L_poll_10
L_polled_11:
    s_mov_b64 exec, -1
L_p3:
    v_lshrrev_b32 v6, 2, v0
    v_lshlrev_b32 v6, 8, v6
    v_and_b32 v8, 3, v0
    v_lshl_add_u32 v4, v8, 4, v6
    v_lshl_add_u32 v6, v8, 3, v6
    s_lshr_b32 s90, s60, 1
    s_mul_i32 s90, s90, 20480
    s_and_b32 s85, s60, 1
    s_lshl_b32 s85, s85, 6
    s_add_u32 s90, s90, s85
    s_add_u32 s90, s90, 4194304
    s_lshr_b32 s89, s60, 2
    s_mul_i32 s89, s89, 20480
    s_and_b32 s85, s60, 3
    s_lshl_b32 s85, s85, 5
    s_add_u32 s89, s89, s85
    s_add_u32 s89, s89, 7340032
    s_mov_b32 s95, 0
    s_mul_i32 s83, s62, 2
    s_mov_b64 s[66:67], -1
    s_mov_b64 s[68:69], -1
L_poll_13:
    s_mov_b64 exec, s[66:67]
    buffer_load_dwordx4 v[44:47], v4, s[48:51], s90 offen sc1
    buffer_load_dwordx2 v[52:53], v6, s[48:51], s89 offen sc1
    s_mov_b64 exec, s[68:69]
    buffer_load_dwordx4 v[48:51], v4, s[48:51], s90 offen offset:128 sc1
    buffer_load_dwordx2 v[54:55], v6, s[48:51], s89 offen offset:128 sc1
    s_mov_b64 exec, -1
L_chk_15:
    s_waitcnt vmcnt(0)
    v_add_u32 v42, v47, v53
    v_add_u32 v43, v51, v55
    v_cmp_ne_u32 s[66:67], s83, v42
    v_cmp_ne_u32 s[68:69], s83, v43
    s_add_u32 s95, s95, 1
    s_or_b64 vcc, s[66:67], s[68:69]
    s_cbranch_scc0 L_polled_14
    s_sleep 1
    s_cmp_lt_u32 s95, 400000
    s_cbranch_scc1 L_poll_13
L_polled_14:
    v_lshlrev_b32 v56, 16, v44
    v_lshlrev_b32 v57, 16, v48
    v_pk_fma_f32 v[56:57], v[56:57], v[26:27], v[10:11]
    s_bitcmp1_b32 s65, 0
    v_cvt_pk_bf16_f32 v56, v56, v57
    s_cbranch_scc1 L_skip_16
    buffer_store_dword v56, v5, s[44:47], s87 offen offset:0 nt
L_skip_16:
    v_and_b32 v58, s86, v44
    v_and_b32 v59, s86, v48
    v_pk_fma_f32 v[58:59], v[58:59], v[28:29], v[12:13]
    s_bitcmp1_b32 s65, 1
    v_cvt_pk_bf16_f32 v58, v58, v59
    s_cbranch_scc1 L_skip_17
    buffer_store_dword v58, v5, s[44:47], s87 offen offset:1280 nt
L_skip_17:
    v_lshlrev_b32 v60, 16, v45
    v_lshlrev_b32 v61, 16, v49
    v_pk_fma_f32 v[60:61], v[60:61], v[30:31], v[14:15]
    s_bitcmp1_b32 s65, 2
    v_cvt_pk_bf16_f32 v60, v60, v61
    s_cbranch_scc1 L_skip_18
    buffer_store_dword v60, v5, s[44:47], s87 offen offset:2560 nt
L_skip_18:
    v_and_b32 v62, s86, v45
    v_and_b32 v63, s86, v49
    v_pk_fma_f32 v[62:63], v[62:63], v[32:33], v[16:17]
    s_bitcmp1_b32 s65, 3
    v_cvt_pk_bf16_f32 v62, v62, v63
    s_cbranch_scc1 L_skip_19
    buffer_store_dword v62, v5, s[44:47], s87 offen offset:3840 nt
L_skip_19:
    v_lshlrev_b32 v64, 16, v46
    v_lshlrev_b32 v65, 16, v50
    v_pk_fma_f32 v[64:65], v[64:65], v[34:35], v[18:19]
    s_bitcmp1_b32 s65, 4
    v_cvt_pk_bf16_f32 v64, v64, v65
    s_cbranch_scc1 L_skip_20
    buffer_store_dword v64, v5, s[44:47], s88 offen offset:0 nt
L_skip_20:
    v_and_b32 v66, s86, v46
    v_and_b32 v67, s86, v50
    v_pk_fma_f32 v[66:67], v[66:67], v[36:37], v[20:21]
    s_bitcmp1_b32 s65, 5
    v_cvt_pk_bf16_f32 v66, v66, v67
    s_cbranch_scc1 L_skip_21
    buffer_store_dword v66, v5, s[44:47], s88 offen offset:1280 nt
L_skip_21:
    v_lshlrev_b32 v68, 16, v52
    v_lshlrev_b32 v69, 16, v54
    v_pk_fma_f32 v[68:69], v[68:69], v[38:39], v[22:23]
    s_bitcmp1_b32 s65, 6
    v_cvt_pk_bf16_f32 v68, v68, v69
    s_cbranch_scc1 L_skip_22
    buffer_store_dword v68, v5, s[44:47], s88 offen offset:2560 nt
L_skip_22:
    v_and_b32 v70, s86, v52
    v_and_b32 v71, s86, v54
    v_pk_fma_f32 v[70:71], v[70:71], v[40:41], v[24:25]
    s_bitcmp1_b32 s65, 7
    v_cvt_pk_bf16_f32 v70, v70, v71
    s_cbranch_scc1 L_skip_23
    buffer_store_dword v70, v5, s[44:47], s88 offen offset:3840 nt
L_skip_23:
    s_branch L_fin
L_aux:
    s_setprio 2
    buffer_load_dword v7, v6, s[48:51], 0 offen sc1
    s_lshl_b32 s85, s60, 3
    v_and_b32 v9, 7, v1
    v_add_u32 v8, s85, v9
    v_lshlrev_b32 v9, 4, v9
    v_sub_u32 v104, 2047, v8
    s_mov_b32 s84, 0x3acccccd
    s_barrier
    v_lshlrev_b32 v4, 2, v1
    v_min_u32 v4, 80, v4
    v_mov_b32 v6, 0
    ds_write_b32 v4, v6 offset:128
    v_lshlrev_b32 v4, 3, v8
    v_lshlrev_b32 v6, 4, v8
    s_waitcnt vmcnt(0)
    v_readfirstlane_b32 s85, v7
    s_nop 0
    s_mul_i32 s85, s85, 0x41c64e6d
    s_add_u32 s62, s85, 0x3039
    s_barrier
    ds_read_b128 v[64:67], v9 offset:640
    ds_read_b128 v[68:71], v9 offset:768
    ds_read_b128 v[72:75], v9 offset:896
    ds_read_b128 v[76:79], v9 offset:1024
    ds_read_b128 v[80:83], v9 offset:1152
    s_waitcnt lgkmcnt(3)
    v_pk_add_f32 v[44:45], v[64:65], v[68:69]
    v_pk_add_f32 v[46:47], v[66:67], v[70:71]
    s_waitcnt lgkmcnt(1)
    v_pk_add_f32 v[72:73], v[72:73], v[76:77]
    v_pk_add_f32 v[74:75], v[74:75], v[78:79]
    s_waitcnt lgkmcnt(0)
    v_pk_add_f32 v[44:45], v[44:45], v[80:81]
    v_pk_add_f32 v[46:47], v[46:47], v[82:83]
    v_pk_add_f32 v[44:45], v[44:45], v[72:73]
    v_pk_add_f32 v[46:47], v[46:47], v[74:75]
    v_pk_mul_f32 v[44:45], v[44:45], s[84:85] op_sel_hi:[1,0]
    v_fma_f32 v45, -v44, v44, v45
    v_max_f32 v45, 0, v45
    v_cvt_pk_bf16_f32 v48, v44, v45
    v_lshlrev_b32 v100, 16, v48
    v_and_b32 v45, s86, v48
    v_add_f32 v45, 0x3727c5ac, v45
    v_cvt_pk_bf16_f32 v48, v45, v45
    v_and_b32 v45, s86, v48
    v_sqrt_f32 v45, v45
    v_fma_f32 v46, -v100, v47, v46
    v_cvt_pk_bf16_f32 v48, v45, v45
    v_and_b32 v45, s86, v48
    v_rcp_f32 v101, v45
    v_mov_b32 v103, s62
    v_mul_f32 v46, v46, v101
    v_cvt_pk_bf16_f32 v48, v46, v46
    v_and_b32 v102, s86, v48
    v_ashrrev_i32 v49, 31, v102
    v_or_b32 v49, 0x80000000, v49
    v_xor_b32 v49, v102, v49
    v_and_or_b32 v104, v49, s86, v104
    v_mov_b32 v105, s62
    s_mov_b32 s84, 8912896
    s_mov_b32 s85, 8978432
    v_lshlrev_b32 v8, 4, v1
    s_mov_b64 exec, 0xff
    buffer_store_dwordx2 v[104:105], v4, s[48:51], s84 offen sc1
    buffer_store_dwordx4 v[100:103], v6, s[48:51], s85 offen sc1
    ds_write_b128 v8, v[100:103] offset:0
    s_mov_b64 exec, -1
    s_setprio 0
    s_waitcnt lgkmcnt(0)
    s_barrier
    s_cmp_lg_u32 s64, 1
    s_cbranch_scc1 L_a2
    s_barrier
    s_mov_b32 s52, s24
    s_mov_b32 s53, s25
    s_mov_b32 s54, 1966080
    s_mov_b32 s55, 0x20000
    s_and_b32 s84, s2, 7
    s_lshr_b32 s85, s2, 3
    s_cmp_ge_u32 s85, 16
    s_cbranch_scc1 L_t_no_24
    s_mul_i32 s91, s84, 160
    s_andn2_b32 s91, s91, 127
    s_mul_i32 s85, s85, 122880
    s_add_u32 s91, s91, s85
    v_lshrrev_b32 v4, 1, v1
    v_mul_u32_u24 v4, 1280, v4
    v_and_b32 v6, 1, v1
    v_lshl_add_u32 v4, v6, 7, v4
    buffer_load_dword v166, v4, s[52:55], s91 offen
    s_add_u32 s91, s91, 40960
    buffer_load_dword v166, v4, s[52:55], s91 offen
    s_add_u32 s91, s91, 40960
    buffer_load_dword v166, v4, s[52:55], s91 offen
L_t_no_24:
    v_and_b32 v4, 7, v1
    v_lshlrev_b32 v4, 3, v4
    s_and_b32 s84, s2, 7
    s_lshl_b32 s84, s84, 7
    s_add_u32 s84, s84, 9109504
    s_mov_b32 s95, 0
    s_mul_i32 s83, s62, 1
L_poll_25:
    buffer_load_dwordx2 v[44:45], v4, s[48:51], s84 offen sc1
L_chk_27:
    s_waitcnt vmcnt(0)
    v_cmp_ne_u32 vcc, s83, v45
    s_add_u32 s95, s95, 1
    s_and_b64 exec, vcc, vcc
    s_cbranch_execz L_polled_26
    s_sleep 8
    s_cmp_lt_u32 s95, 400000
    s_cbranch_scc1 L_poll_25
L_polled_26:
    s_mov_b64 exec, -1
    v_lshrrev_b32 v4, 3, v44
    v_and_b32 v6, 7, v44
    v_lshlrev_b32 v6, v6, 1
    v_cmp_eq_u32 vcc, s60, v4
    s_nop 1
    v_cndmask_b32 v6, 0, v6, vcc
    s_nop 1
    v_or_b32_dpp v6, v6, v6 row_half_mirror row_mask:0xf bank_mask:0xf
    s_nop 1
    v_or_b32_dpp v6, v6, v6 quad_perm:[1,0,3,2] row_mask:0xf bank_mask:0xf
    s_nop 1
    v_or_b32_dpp v6, v6, v6 quad_perm:[2,3,0,1] row_mask:0xf bank_mask:0xf
    v_mov_b32 v4, 256
    ds_write_b32 v4, v6
    s_waitcnt lgkmcnt(0)
    s_branch L_fin
L_a2:
    s_cmp_lg_u32 s64, 2
    s_cbranch_scc1 L_a3
    v_mov_b32 v48, 0x3f803f80
    v_mov_b32 v49, 0x3f803f80
    v_lshlrev_b32 v4, 3, v1
    v_add_u32 v4, 93696, v4
    ds_write_b64 v4, v[48:49]
    s_barrier
    v_and_b32 v4, 7, v1
    v_lshlrev_b32 v4, 3, v4
    s_and_b32 s84, s2, 7
    s_lshl_b32 s84, s84, 7
    s_add_u32 s84, s84, 9109504
    s_mov_b32 s95, 0
    s_mul_i32 s83, s62, 1
L_poll_28:
    buffer_load_dwordx2 v[44:45], v4, s[48:51], s84 offen sc1
L_chk_30:
    s_waitcnt vmcnt(0)
    v_cmp_ne_u32 vcc, s83, v45
    s_add_u32 s95, s95, 1
    s_and_b64 exec, vcc, vcc
    s_cbranch_execz L_polled_29
    s_sleep 1
    s_cmp_lt_u32 s95, 400000
    s_cbranch_scc1 L_poll_28
L_polled_29:
    s_mov_b64 exec, -1
    v_lshrrev_b32 v6, 3, v1
    v_lshlrev_b32 v4, 2, v6
    ds_bpermute_b32 v46, v4, v44
    v_lshlrev_b32 v43, 4, v44
    s_mov_b32 s89, 8978432
    v_and_b32 v8, 7, v1
    v_mul_u32_u24 v2, 1312, v6
    v_lshl_add_u32 v2, v8, 4, v2
    v_add_u32 v2, 83200, v2
    s_waitcnt lgkmcnt(0)
    v_mul_u32_u24 v46, 1280, v46
    v_lshl_add_u32 v46, v8, 4, v46
    buffer_load_dwordx4 v[64:67], v46, s[32:35], 0 offen offset:0
    buffer_load_dwordx4 v[68:71], v46, s[32:35], 0 offen offset:128
    buffer_load_dwordx4 v[72:75], v46, s[32:35], 0 offen offset:256
    buffer_load_dwordx4 v[76:79], v46, s[32:35], 0 offen offset:384
    buffer_load_dwordx4 v[80:83], v46, s[32:35], 0 offen offset:512
    buffer_load_dwordx4 v[84:87], v46, s[32:35], 0 offen offset:640
    buffer_load_dwordx4 v[88:91], v46, s[32:35], 0 offen offset:768
    buffer_load_dwordx4 v[92:95], v46, s[32:35], 0 offen offset:896
    buffer_load_dwordx4 v[96:99], v46, s[32:35], 0 offen offset:1024
    buffer_load_dwordx4 v[100:103], v46, s[32:35], 0 offen offset:1152
    buffer_load_dwordx4 v[48:51], v43, s[48:51], s89 offen sc1
    v_lshrrev_b32 v4, 3, v44
    v_and_b32 v6, 7, v44
    v_lshlrev_b32 v6, v6, 1
    v_cmp_eq_u32 vcc, s60, v4
    s_nop 1
    v_cndmask_b32 v6, 0, v6, vcc
    s_nop 1
    v_or_b32_dpp v6, v6, v6 row_half_mirror row_mask:0xf bank_mask:0xf
    s_nop 1
    v_or_b32_dpp v6, v6, v6 quad_perm:[1,0,3,2] row_mask:0xf bank_mask:0xf
    s_nop 1
    v_or_b32_dpp v6, v6, v6 quad_perm:[2,3,0,1] row_mask:0xf bank_mask:0xf
    v_mov_b32 v4, 256
    ds_write_b32 v4, v6
    v_lshlrev_b32 v8, 3, v8
    s_waitcnt vmcnt(10)
    ds_write_b128 v2, v[64:67] offset:0
    s_waitcnt vmcnt(9)
    ds_write_b128 v2, v[68:71] offset:128
    s_waitcnt vmcnt(8)
    ds_write_b128 v2, v[72:75] offset:256
    s_waitcnt vmcnt(7)
    ds_write_b128 v2, v[76:79] offset:384
    s_waitcnt vmcnt(6)
    ds_write_b128 v2, v[80:83] offset:512
    s_waitcnt vmcnt(5)
    ds_write_b128 v2, v[84:87] offset:640
    s_waitcnt vmcnt(4)
    ds_write_b128 v2, v[88:91] offset:768
    s_waitcnt vmcnt(3)
    ds_write_b128 v2, v[92:95] offset:896
    s_waitcnt vmcnt(2)
    ds_write_b128 v2, v[96:99] offset:1024
    s_waitcnt vmcnt(1)
    ds_write_b128 v2, v[100:103] offset:1152
    s_mov_b32 s95, 0
    s_mul_i32 s83, s62, 1
    s_branch L_chk_33
L_poll_31:
    buffer_load_dwordx4 v[48:51], v43, s[48:51], s89 offen sc1
L_chk_33:
    s_waitcnt vmcnt(0)
    v_cmp_ne_u32 vcc, s83, v51
    s_add_u32 s95, s95, 1
    s_and_b64 exec, vcc, vcc
    s_cbranch_execz L_polled_32
    s_cmp_lt_u32 s95, 400000
    s_cbranch_scc1 L_poll_31
L_polled_32:
    s_mov_b64 exec, -1
    ds_write_b64 v8, v[48:49] offset:272
    s_waitcnt lgkmcnt(0)
    s_barrier
    s_branch L_fin
L_a3:
    s_cmp_lg_u32 s64, 3
    s_cbranch_scc1 L_fin
    v_and_b32 v4, 7, v1
    v_lshlrev_b32 v4, 3, v4
    s_and_b32 s84, s2, 7
    s_lshl_b32 s84, s84, 7
    s_add_u32 s84, s84, 9109504
    s_mov_b32 s95, 0
    s_mul_i32 s83, s62, 1
L_poll_34:
    buffer_load_dwordx2 v[44:45], v4, s[48:51], s84 offen sc1
L_chk_36:
    s_waitcnt vmcnt(0)
    v_cmp_ne_u32 vcc, s83, v45
    s_add_u32 s95, s95, 1
    s_and_b64 exec, vcc, vcc
    s_cbranch_execz L_polled_35
    s_sleep 1
    s_cmp_lt_u32 s95, 400000
    s_cbranch_scc1 L_poll_34
L_polled_35:
    s_mov_b64 exec, -1
    v_lshrrev_b32 v4, 3, v44
    v_and_b32 v6, 7, v44
    v_lshlrev_b32 v6, v6, 1
    v_cmp_eq_u32 vcc, s60, v4
    s_nop 1
    v_cndmask_b32 v6, 0, v6, vcc
    s_nop 1
    v_or_b32_dpp v6, v6, v6 row_half_mirror row_mask:0xf bank_mask:0xf
    s_nop 1
    v_or_b32_dpp v6, v6, v6 quad_perm:[1,0,3,2] row_mask:0xf bank_mask:0xf
    s_nop 1
    v_or_b32_dpp v6, v6, v6 quad_perm:[2,3,0,1] row_mask:0xf bank_mask:0xf
    v_mov_b32 v4, 256
    ds_write_b32 v4, v6
    s_waitcnt lgkmcnt(0)
    s_barrier
    v_lshrrev_b32 v6, 4, v1
    s_lshl_b32 s84, s63, 5
    s_mov_b32 s89, 8978432
    v_mov_b32 v61, v44
    v_mul_u32_u24 v62, 1280, v61
    v_lshl_add_u32 v62, v6, 3, v62
    v_add_u32 v62, s84, v62
    buffer_load_dwordx2 v[120:121], v62, s[32:35], 0 offen
    v_lshlrev_b32 v43, 4, v61
    s_mov_b32 s95, 0
    s_mul_i32 s83, s62, 1
L_poll_37:
    buffer_load_dwordx4 v[80:83], v43, s[48:51], s89 offen sc1
L_chk_39:
    s_waitcnt vmcnt(0)
    v_cmp_ne_u32 vcc, s83, v83
    s_add_u32 s95, s95, 1
    s_and_b64 exec, vcc, vcc
    s_cbranch_execz L_polled_38
    s_cmp_lt_u32 s95, 400000
    s_cbranch_scc1 L_poll_37
L_polled_38:
    s_mov_b64 exec, -1
    s_mov_b32 s84, 0xbfb8aa3b
    v_mul_f32 v42, s84, v82
    v_exp_f32 v42, v42
    v_lshlrev_b32 v116, 16, v120
    v_and_b32 v117, s86, v120
    v_add_f32 v42, 1.0, v42
    v_rcp_f32 v42, v42
    v_lshlrev_b32 v118, 16, v121
    v_and_b32 v119, s86, v121
    v_cvt_pk_bf16_f32 v42, v42, v42
    v_and_b32 v82, s86, v42
    v_sub_f32 v112, v116, v80
    v_sub_f32 v113, v117, v80
    v_sub_f32 v114, v118, v80
    v_sub_f32 v115, v119, v80
    v_cvt_pk_bf16_f32 v42, v112, v113
    v_cvt_pk_bf16_f32 v43, v114, v115
    v_lshlrev_b32 v112, 16, v42
    v_and_b32 v113, s86, v42
    v_lshlrev_b32 v114, 16, v43
    v_and_b32 v115, s86, v43
    v_mul_f32 v112, v112, v81
    v_mul_f32 v113, v113, v81
    v_mul_f32 v114, v114, v81
    v_mul_f32 v115, v115, v81
    v_cvt_pk_bf16_f32 v42, v112, v113
    v_cvt_pk_bf16_f32 v43, v114, v115
    v_lshlrev_b32 v112, 16, v42
    v_and_b32 v113, s86, v42
    v_lshlrev_b32 v114, 16, v43
    v_and_b32 v115, s86, v43
    v_lshrrev_b32 v8, 1, v6
    v_lshlrev_b32 v8, 8, v8
    s_lshl_b32 s85, s63, 9
    v_add_u32 v8, s85, v8
    v_and_b32 v9, 1, v6
    v_lshrrev_b32 v4, 4, v61
    v_mul_u32_u24 v122, 20480, v4
    v_bfe_u32 v4, v61, 3, 1
    v_lshl_add_u32 v122, v4, 6, v122
    v_lshl_add_u32 v122, v9, 5, v122
    v_add_u32 v122, v8, v122
    v_add_u32 v122, 4194304, v122
    v_lshrrev_b32 v4, 5, v61
    v_mul_u32_u24 v123, 20480, v4
    v_bfe_u32 v4, v61, 3, 2
    v_lshl_add_u32 v123, v4, 5, v123
    v_lshl_add_u32 v123, v9, 4, v123
    v_add_u32 v123, v8, v123
    v_add_u32 v123, 7340032, v123
    v_bfe_u32 v4, v61, 1, 2
    v_cmp_eq_u32 s[92:93], 1, v4
    v_cmp_eq_u32 s[66:67], 2, v4
    v_cmp_eq_u32 s[68:69], 3, v4
    v_and_b32 v4, 1, v61
    v_lshlrev_b32 v4, 4, v4
    v_sub_u32 v124, 16, v4
    v_lshlrev_b32 v4, 4, v1
    s_barrier
    buffer_load_dwordx4 v[64:67], v122, s[48:51], 0 offen offset:0 sc1
    buffer_load_dwordx2 v[84:85], v123, s[48:51], 0 offen offset:0 sc1
    buffer_load_dwordx4 v[68:71], v122, s[48:51], 0 offen offset:128 sc1
    buffer_load_dwordx2 v[86:87], v123, s[48:51], 0 offen offset:128 sc1
    buffer_load_dwordx4 v[72:75], v122, s[48:51], 0 offen offset:16 sc1
    buffer_load_dwordx2 v[88:89], v123, s[48:51], 0 offen offset:8 sc1
    buffer_load_dwordx4 v[76:79], v122, s[48:51], 0 offen offset:144 sc1
    buffer_load_dwordx2 v[90:91], v123, s[48:51], 0 offen offset:136 sc1
    ds_read_b128 v[128:131], v4 offset:50432
    ds_read_b128 v[132:135], v4 offset:51456
    ds_read_b128 v[136:139], v4 offset:52480
    ds_read_b128 v[140:143], v4 offset:53504
    s_waitcnt lgkmcnt(0)
    v_pk_add_f32 v[128:129], v[128:129], v[132:133]
    v_pk_add_f32 v[130:131], v[130:131], v[134:135]
    v_pk_add_f32 v[136:137], v[136:137], v[140:141]
    v_pk_add_f32 v[138:139], v[138:139], v[142:143]
    v_pk_add_f32 v[128:129], v[128:129], v[136:137]
    v_pk_add_f32 v[130:131], v[130:131], v[138:139]
    v_cvt_pk_bf16_f32 v42, v128, v129
    v_cvt_pk_bf16_f32 v43, v130, v131
    v_lshlrev_b32 v128, 16, v42
    v_and_b32 v129, s86, v42
    v_lshlrev_b32 v130, 16, v43
    v_and_b32 v131, s86, v43
    v_mul_f32 v128, v128, v82
    v_mul_f32 v129, v129, v82
    v_mul_f32 v130, v130, v82
    v_mul_f32 v131, v131, v82
    v_cvt_pk_bf16_f32 v42, v128, v129
    v_cvt_pk_bf16_f32 v43, v130, v131
    v_lshlrev_b32 v128, 16, v42
    v_and_b32 v129, s86, v42
    v_lshlrev_b32 v130, 16, v43
    v_and_b32 v131, s86, v43
    v_add_f32 v128, v128, v112
    v_add_f32 v129, v129, v113
    v_add_f32 v130, v130, v114
    v_add_f32 v131, v131, v115
    v_cvt_pk_bf16_f32 v42, v128, v129
    v_cvt_pk_bf16_f32 v43, v130, v131
    v_lshlrev_b32 v128, 16, v42
    v_and_b32 v129, s86, v42
    v_lshlrev_b32 v130, 16, v43
    v_and_b32 v131, s86, v43
    v_mul_f32 v132, s84, v128
    v_mul_f32 v133, s84, v129
    v_mul_f32 v134, s84, v130
    v_mul_f32 v135, s84, v131
    v_exp_f32 v132, v132
    v_exp_f32 v133, v133
    v_exp_f32 v134, v134
    v_exp_f32 v135, v135
    v_add_f32 v132, 1.0, v132
    v_add_f32 v133, 1.0, v133
    v_add_f32 v134, 1.0, v134
    v_add_f32 v135, 1.0, v135
    v_rcp_f32 v132, v132
    v_rcp_f32 v133, v133
    v_rcp_f32 v134, v134
    v_rcp_f32 v135, v135
    v_mul_f32 v128, v128, v132
    v_mul_f32 v129, v129, v133
    v_mul_f32 v130, v130, v134
    v_mul_f32 v131, v131, v135
    v_cvt_pk_bf16_f32 v42, v128, v129
    v_cvt_pk_bf16_f32 v43, v130, v131
    v_lshlrev_b32 v128, 16, v42
    v_and_b32 v129, s86, v42
    v_lshlrev_b32 v130, 16, v43
    v_and_b32 v131, s86, v43
    s_mov_b32 s95, 0
    s_mul_i32 s83, s62, 8
    s_branch L_chk_42
L_poll_40:
    buffer_load_dwordx4 v[64:67], v122, s[48:51], 0 offen offset:0 sc1
    buffer_load_dwordx2 v[84:85], v123, s[48:51], 0 offen offset:0 sc1
    buffer_load_dwordx4 v[68:71], v122, s[48:51], 0 offen offset:128 sc1
    buffer_load_dwordx2 v[86:87], v123, s[48:51], 0 offen offset:128 sc1
    buffer_load_dwordx4 v[72:75], v122, s[48:51], 0 offen offset:16 sc1
    buffer_load_dwordx2 v[88:89], v123, s[48:51], 0 offen offset:8 sc1
    buffer_load_dwordx4 v[76:79], v122, s[48:51], 0 offen offset:144 sc1
    buffer_load_dwordx2 v[90:91], v123, s[48:51], 0 offen offset:136 sc1
L_chk_42:
    s_waitcnt vmcnt(0)
    v_add_u32 v42, v67, v71
    v_add3_u32 v42, v42, v75, v79
    v_add3_u32 v42, v42, v85, v87
    v_add3_u32 v42, v42, v89, v91
    v_cmp_ne_u32 vcc, s83, v42
    s_add_u32 s95, s95, 1
    s_and_b64 exec, vcc, vcc
    s_cbranch_execz L_polled_41
    s_sleep 2
    s_cmp_lt_u32 s95, 400000
    s_cbranch_scc1 L_poll_40
L_polled_41:
    s_mov_b64 exec, -1
    v_cndmask_b32 v64, v64, v65, s[92:93]
    v_cndmask_b32 v68, v68, v69, s[92:93]
    v_cndmask_b32 v72, v72, v73, s[92:93]
    v_cndmask_b32 v76, v76, v77, s[92:93]
    v_cndmask_b32 v64, v64, v66, s[66:67]
    v_cndmask_b32 v68, v68, v70, s[66:67]
    v_cndmask_b32 v72, v72, v74, s[66:67]
    v_cndmask_b32 v76, v76, v78, s[66:67]
    v_cndmask_b32 v64, v64, v84, s[68:69]
    v_cndmask_b32 v68, v68, v86, s[68:69]
    v_cndmask_b32 v72, v72, v88, s[68:69]
    v_cndmask_b32 v76, v76, v90, s[68:69]
    v_lshlrev_b32 v64, v124, v64
    v_and_b32 v64, s86, v64
    v_mul_f32 v112, v112, v64
    v_lshlrev_b32 v68, v124, v68
    v_and_b32 v68, s86, v68
    v_mul_f32 v113, v113, v68
    v_lshlrev_b32 v72, v124, v72
    v_and_b32 v72, s86, v72
    v_mul_f32 v114, v114, v72
    v_lshlrev_b32 v76, v124, v76
    v_and_b32 v76, s86, v76
    v_mul_f32 v115, v115, v76
    v_cvt_pk_bf16_f32 v42, v112, v113
    v_cvt_pk_bf16_f32 v43, v114, v115
    v_lshlrev_b32 v112, 16, v42
    v_and_b32 v113, s86, v42
    v_lshlrev_b32 v114, 16, v43
    v_and_b32 v115, s86, v43
    v_mul_f32 v112, v112, v128
    v_mul_f32 v113, v113, v129
    v_mul_f32 v114, v114, v130
    v_mul_f32 v115, v115, v131
    v_cvt_pk_bf16_f32 v42, v112, v113
    v_cvt_pk_bf16_f32 v43, v114, v115
    v_lshlrev_b32 v112, 16, v42
    v_and_b32 v113, s86, v42
    v_lshlrev_b32 v114, 16, v43
    v_and_b32 v115, s86, v43
    v_add_f32 v112, v112, v116
    v_add_f32 v113, v113, v117
    v_add_f32 v114, v114, v118
    v_add_f32 v115, v115, v119
    v_cvt_pk_bf16_f32 v112, v112, v113
    v_cvt_pk_bf16_f32 v113, v114, v115
    s_mov_b32 s82, 0x00ff00ff
    s_mov_b32 exec_lo, s82
    s_mov_b32 exec_hi, s82
    buffer_store_dwordx2 v[112:113], v62, s[44:47], 0 offen nt
    s_mov_b64 exec, -1
    s_branch L_fin
L_role:
    buffer_load_dword v7, v6, s[48:51], 0 offen sc1
    v_subrev_u32 v0, 320, v0
    s_sub_u32 s61, s3, 6
    s_barrier
    s_waitcnt vmcnt(0)
    v_readfirstlane_b32 s85, v7
    s_nop 0
    s_mul_i32 s85, s85, 0x41c64e6d
    s_add_u32 s62, s85, 0x3039
    s_barrier
    s_cmp_lg_u32 s64, 1
    s_cbranch_scc1 L_r2
    s_lshr_b32 s92, s63, 1
    s_lshl_b32 s92, s92, 3
    s_and_b32 s93, s63, 1
    s_add_u32 s92, s92, s93
    s_lshl_b32 s93, s61, 1
    s_add_u32 s92, s92, s93
    s_lshl_b32 s85, s92, 12
    s_lshl_b32 s92, s92, 1
    s_and_b32 s93, s92, 2
    s_lshl_b32 s93, s93, 3
    s_andn2_b32 s92, s92, 3
    s_load_dword s94, s[14:15], s92
    s_mov_b32 s52, s12
    s_mov_b32 s53, s13
    s_mov_b32 s54, 2621440
    s_mov_b32 s55, 0x20000
    v_lshlrev_b32 v6, 4, v1
    v_add_u32 v7, s85, v6
    buffer_load_dwordx4 v[74:77], v7, s[52:55], 0 offen offset:0 nt
    buffer_load_dwordx4 v[82:85], v7, s[52:55], 0 offen offset:1024 nt
    buffer_load_dwordx4 v[90:93], v7, s[52:55], 0 offen offset:2048 nt
    buffer_load_dwordx4 v[98:101], v7, s[52:55], 0 offen offset:3072 nt
    s_mul_i32 s84, s61, 16640
    s_add_u32 s84, s84, 19712
    v_add_u32 v20, s84, v6
    s_mul_i32 s85, s61, 4576
    s_add_u32 s85, s85, 1280
    v_mov_b32 v126, 0
    v_mov_b32 v127, 0
    v_mov_b32 v128, 0
    v_mov_b32 v129, 0
    v_mov_b32 v72, 0
    v_mov_b32 v73, 0
    v_min_u32 v8, 29, v1
    v_lshl_add_u32 v8, v8, 4, s85
    ds_write_b128 v8, v[126:129]
    v_and_b32 v6, 7, v1
    v_lshrrev_b32 v8, 1, v6
    v_mul_u32_u24 v8, 4160, v8
    v_and_b32 v6, 1, v6
    v_lshl_add_u32 v8, v6, 4, v8
    v_add_u32 v8, s84, v8
    ds_write_b128 v8, v[126:129]
    v_lshrrev_b32 v6, 4, v1
    v_and_b32 v8, 15, v1
    v_add_u32 v9, 1, v8
    v_sub_u32 v10, 0, v9
    v_and_b32 v10, 3, v10
    v_add_u32 v9, v9, v10
    v_lshl_add_u32 v9, v6, 3, v9
    v_mul_u32_u24 v10, 4160, v10
    v_lshl_add_u32 v9, v9, 1, v10
    v_add_u32 v2, s84, v9
    v_lshlrev_b32 v9, 1, v8
    v_sub_u32 v9, v9, v6
    v_add_u32 v9, 3, v9
    v_lshl_add_u32 v3, v9, 4, s85
    v_and_b32 v9, 1, v6
    v_lshlrev_b32 v9, 9, v9
    v_lshrrev_b32 v10, 1, v6
    v_lshl_add_u32 v9, v10, 8, v9
    v_lshl_add_u32 v9, v8, 4, v9
    s_mul_i32 s84, s61, 4160
    s_add_u32 s84, s84, 87296
    v_add_u32 v4, s84, v9
    v_lshlrev_b32 v9, 3, v6
    v_add_u32 v9, v9, v8
    v_sub_u32 v9, 15, v9
    v_and_b32 v10, 1, v9
    v_lshlrev_b32 v10, 4, v10
    v_ashrrev_i32 v9, 1, v9
    s_lshr_b32 s85, s63, 2
    s_mul_i32 s85, s85, 98304
    s_lshl_b32 s90, s63, 5
    s_and_b32 s90, s90, 64
    s_add_u32 s85, s85, s90
    s_and_b32 s91, s63, 1
    s_lshl_b32 s90, s91, 15
    s_add_u32 s90, s90, s85
    s_lshl_b32 s91, s91, 3
    s_add_u32 s85, s85, s91
    s_add_u32 s85, s85, 65536
    v_lshrrev_b32 v21, 2, v0
    v_and_b32 v22, 3, v0
    v_mul_u32_u24 v23, 4576, v22
    v_lshl_add_u32 v23, v21, 4, v23
    v_lshlrev_b32 v22, 4, v22
    v_lshl_add_u32 v21, v21, 7, v22
    v_add_u32 v22, s85, v21
    v_add_u32 v21, s90, v21
    v_and_b32 v24, 7, v1
    v_lshlrev_b32 v24, 12, v24
    v_add_u32 v24, s90, v24
    s_movk_i32 s89, 0x2000
    s_movk_i32 s90, 0x4000
    s_movk_i32 s91, 0x6000
    s_waitcnt lgkmcnt(0)
    s_lshr_b32 s94, s94, s93
    s_and_b32 s94, s94, 0xffff
    v_lshlrev_b32 v10, v10, s94
    v_cmp_eq_u32 vcc, 0, v9
    s_nop 1
    v_cndmask_b32 v26, 0, v10, vcc
    v_cmp_eq_u32 vcc, 1, v9
    s_nop 1
    v_cndmask_b32 v27, 0, v10, vcc
    v_cmp_eq_u32 vcc, 2, v9
    s_nop 1
    v_cndmask_b32 v28, 0, v10, vcc
    v_cmp_eq_u32 vcc, 3, v9
    s_nop 1
    v_cndmask_b32 v29, 0, v10, vcc
    v_and_b32 v8, 3, v0
    v_lshrrev_b32 v9, 2, v0
    v_add_u32 v9, 192, v9
    v_mul_u32_u24 v11, 4160, v8
    v_lshrrev_b32 v10, 5, v9
    v_lshl_add_u32 v11, v10, 9, v11
    v_and_b32 v10, 1, v9
    v_lshl_add_u32 v11, v10, 8, v11
    v_bfe_u32 v10, v9, 1, 4
    v_lshl_add_u32 v11, v10, 4, v11
    v_lshrrev_b32 v5, 2, v9
    v_mul_u32_u24 v5, 20480, v5
    v_and_b32 v8, 15, v0
    v_lshl_add_u32 v5, v8, 3, v5
    v_lshrrev_b32 v1, 1, v9
    v_mul_u32_u24 v1, 20480, v1
    v_and_b32 v8, 7, v0
    v_lshl_add_u32 v1, v8, 4, v1
    v_add_u32 v0, 87296, v11
    s_lshl_b32 s93, s63, 7
    s_add_u32 s92, s93, 4194304
    s_add_u32 s93, s93, 7340032
    s_barrier
    s_waitcnt vmcnt(0)
    v_mov_b32_dpp v80, v76 wave_ror:1 row_mask:0xf bank_mask:0xf
    v_mov_b32_dpp v81, v77 wave_ror:1 row_mask:0xf bank_mask:0xf
    v_mov_b32_dpp v88, v84 wave_ror:1 row_mask:0xf bank_mask:0xf
    v_mov_b32_dpp v89, v85 wave_ror:1 row_mask:0xf bank_mask:0xf
    v_mov_b32_dpp v96, v92 wave_ror:1 row_mask:0xf bank_mask:0xf
    v_mov_b32_dpp v97, v93 wave_ror:1 row_mask:0xf bank_mask:0xf
    v_mov_b32_dpp v72, v76 wave_shr:1 row_mask:0xf bank_mask:0xf
    v_mov_b32_dpp v73, v77 wave_shr:1 row_mask:0xf bank_mask:0xf
    v_mov_b32_dpp v80, v84 wave_shr:1 row_mask:0xf bank_mask:0xf
    v_mov_b32_dpp v81, v85 wave_shr:1 row_mask:0xf bank_mask:0xf
    v_mov_b32_dpp v88, v92 wave_shr:1 row_mask:0xf bank_mask:0xf
    v_mov_b32_dpp v89, v93 wave_shr:1 row_mask:0xf bank_mask:0xf
    v_mov_b32_dpp v96, v100 wave_shr:1 row_mask:0xf bank_mask:0xf
    v_mov_b32_dpp v97, v101 wave_shr:1 row_mask:0xf bank_mask:0xf
    ds_write_b128 v20, v[74:77] offset:32
    v_alignbyte_b32 v102, v74, v73, 2
    v_alignbyte_b32 v103, v75, v74, 2
    v_alignbyte_b32 v104, v76, v75, 2
    v_alignbyte_b32 v105, v77, v76, 2
    v_mov_b32 v106, v73
    v_mov_b32 v107, v74
    v_mov_b32 v108, v75
    v_mov_b32 v109, v76
    v_alignbyte_b32 v110, v73, v72, 2
    v_alignbyte_b32 v111, v74, v73, 2
    v_alignbyte_b32 v112, v75, v74, 2
    v_alignbyte_b32 v113, v76, v75, 2
    ds_write_b128 v20, v[102:105] offset:4192
    ds_write_b128 v20, v[106:109] offset:8352
    ds_write_b128 v20, v[110:113] offset:12512
    ds_write_b128 v20, v[82:85] offset:1056
    v_alignbyte_b32 v114, v82, v81, 2
    v_alignbyte_b32 v115, v83, v82, 2
    v_alignbyte_b32 v116, v84, v83, 2
    v_alignbyte_b32 v117, v85, v84, 2
    v_mov_b32 v118, v81
    v_mov_b32 v119, v82
    v_mov_b32 v120, v83
    v_mov_b32 v121, v84
    v_alignbyte_b32 v122, v81, v80, 2
    v_alignbyte_b32 v123, v82, v81, 2
    v_alignbyte_b32 v124, v83, v82, 2
    v_alignbyte_b32 v125, v84, v83, 2
    ds_write_b128 v20, v[114:117] offset:5216
    ds_write_b128 v20, v[118:121] offset:9376
    ds_write_b128 v20, v[122:125] offset:13536
    buffer_load_dwordx4 v[134:137], v21, s[48:51], 0 offen sc1
    buffer_load_dwordx2 v[150:151], v22, s[48:51], 0 offen sc1
    buffer_load_dwordx4 v[138:141], v21, s[48:51], s89 offen sc1
    buffer_load_dwordx2 v[152:153], v22, s[48:51], s89 offen sc1
    buffer_load_dwordx4 v[142:145], v21, s[48:51], s90 offen sc1
    buffer_load_dwordx2 v[154:155], v22, s[48:51], s90 offen sc1
    buffer_load_dwordx4 v[146:149], v21, s[48:51], s91 offen sc1
    buffer_load_dwordx2 v[156:157], v22, s[48:51], s91 offen sc1
L_gather_late_43:
    ds_write_b128 v20, v[90:93] offset:2080
    v_alignbyte_b32 v102, v90, v89, 2
    v_alignbyte_b32 v103, v91, v90, 2
    v_alignbyte_b32 v104, v92, v91, 2
    v_alignbyte_b32 v105, v93, v92, 2
    v_mov_b32 v106, v89
    v_mov_b32 v107, v90
    v_mov_b32 v108, v91
    v_mov_b32 v109, v92
    v_alignbyte_b32 v110, v89, v88, 2
    v_alignbyte_b32 v111, v90, v89, 2
    v_alignbyte_b32 v112, v91, v90, 2
    v_alignbyte_b32 v113, v92, v91, 2
    ds_write_b128 v20, v[102:105] offset:6240
    ds_write_b128 v20, v[106:109] offset:10400
    ds_write_b128 v20, v[110:113] offset:14560
    ds_write_b128 v20, v[98:101] offset:3104
    v_alignbyte_b32 v114, v98, v97, 2
    v_alignbyte_b32 v115, v99, v98, 2
    v_alignbyte_b32 v116, v100, v99, 2
    v_alignbyte_b32 v117, v101, v100, 2
    v_mov_b32 v118, v97
    v_mov_b32 v119, v98
    v_mov_b32 v120, v99
    v_mov_b32 v121, v100
    v_alignbyte_b32 v122, v97, v96, 2
    v_alignbyte_b32 v123, v98, v97, 2
    v_alignbyte_b32 v124, v99, v98, 2
    v_alignbyte_b32 v125, v100, v99, 2
    ds_write_b128 v20, v[114:117] offset:7264
    ds_write_b128 v20, v[118:121] offset:11424
    ds_write_b128 v20, v[122:125] offset:15584
    s_mov_b32 s95, 0
    s_mul_i32 s83, s62, 2
    s_mov_b64 s[66:67], -1
    s_mov_b64 s[68:69], -1
    s_mov_b64 s[70:71], -1
    s_mov_b64 s[72:73], -1
    s_branch L_chk_47
L_poll_45:
    s_mov_b64 exec, s[66:67]
    buffer_load_dwordx4 v[134:137], v21, s[48:51], 0 offen sc1
    buffer_load_dwordx2 v[150:151], v22, s[48:51], 0 offen sc1
    s_mov_b64 exec, s[68:69]
    buffer_load_dwordx4 v[138:141], v21, s[48:51], s89 offen sc1
    buffer_load_dwordx2 v[152:153], v22, s[48:51], s89 offen sc1
    s_mov_b64 exec, s[70:71]
    buffer_load_dwordx4 v[142:145], v21, s[48:51], s90 offen sc1
    buffer_load_dwordx2 v[154:155], v22, s[48:51], s90 offen sc1
    s_mov_b64 exec, s[72:73]
    buffer_load_dwordx4 v[146:149], v21, s[48:51], s91 offen sc1
    buffer_load_dwordx2 v[156:157], v22, s[48:51], s91 offen sc1
    s_mov_b64 exec, -1
L_chk_47:
    s_waitcnt vmcnt(0)
    v_add_u32 v30, v137, v151
    v_add_u32 v31, v141, v153
    v_add_u32 v32, v145, v155
    v_add_u32 v33, v149, v157
    v_cmp_ne_u32 s[66:67], s83, v30
    v_cmp_ne_u32 s[68:69], s83, v31
    v_cmp_ne_u32 s[70:71], s83, v32
    v_cmp_ne_u32 s[72:73], s83, v33
    s_add_u32 s95, s95, 1
    s_or_b64 vcc, s[66:67], s[68:69]
    s_or_b64 vcc, vcc, s[70:71]
    s_or_b64 vcc, vcc, s[72:73]
    s_cbranch_scc0 L_polled_46
    s_sleep 1
    s_cmp_lt_u32 s95, 400000
    s_cbranch_scc1 L_poll_45
L_polled_46:
    v_mov_b32 v137, v150
    v_mov_b32 v141, v152
    v_mov_b32 v145, v154
    v_mov_b32 v149, v156
    ds_write_b128 v23, v[134:137] offset:1760
    ds_write_b128 v23, v[138:141] offset:2784
    ds_write_b128 v23, v[142:145] offset:3808
    ds_write_b128 v23, v[146:149] offset:4832
    v_mov_b32 v70, v26
    v_mov_b32 v71, v27
    v_mov_b32 v72, v28
    v_mov_b32 v73, v29
    s_waitcnt lgkmcnt(0)
    s_barrier
    ds_read_b128 v[66:69], v3 offset:4032
    ds_read_b128 v[62:65], v3 offset:3520
    ds_read_b128 v[58:61], v3 offset:3008
    ds_read_b128 v[54:57], v3 offset:2496
    ds_read_b128 v[50:53], v3 offset:1984
    ds_read_b128 v[46:49], v3 offset:1472
    ds_read_b128 v[42:45], v3 offset:960
    ds_read_b128 v[38:41], v3 offset:448
    ds_read_b64 v[6:7], v2 offset:0
    ds_read_b64 v[8:9], v2 offset:8
    ds_read_b64 v[10:11], v2 offset:512
    ds_read_b64 v[12:13], v2 offset:520
    ds_read_b64 v[14:15], v2 offset:1024
    ds_read_b64 v[16:17], v2 offset:1032
    s_waitcnt lgkmcnt(6)
    v_mfma_f32_16x16x32_bf16 v[162:165], v[70:73], v[66:69], 0
    ds_read_b64 v[18:19], v2 offset:1536
    ds_read_b64 v[20:21], v2 offset:1544
    v_mfma_f32_16x16x32_bf16 v[158:161], v[70:73], v[62:65], 0
    ds_read_b64 v[22:23], v2 offset:2048
    ds_read_b64 v[24:25], v2 offset:2056
    v_mfma_f32_16x16x32_bf16 v[154:157], v[70:73], v[58:61], 0
    ds_read_b64 v[26:27], v2 offset:2560
    ds_read_b64 v[28:29], v2 offset:2568
    v_mfma_f32_16x16x32_bf16 v[150:153], v[70:73], v[54:57], 0
    v_mfma_f32_16x16x32_bf16 v[146:149], v[70:73], v[50:53], 0
    v_mfma_f32_16x16x32_bf16 v[142:145], v[70:73], v[46:49], 0
    v_mfma_f32_16x16x32_bf16 v[138:141], v[70:73], v[42:45], 0
    v_mfma_f32_16x16x32_bf16 v[134:137], v[70:73], v[38:41], 0
    s_waitcnt lgkmcnt(0)
    v_mfma_f32_16x16x32_bf16 v[154:157], v[6:9], v[58:61], v[154:157]
    ds_read_b128 v[122:125], v3 offset:2944
    v_mfma_f32_16x16x32_bf16 v[150:153], v[6:9], v[54:57], v[150:153]
    ds_read_b64 v[70:71], v2 offset:64
    v_mfma_f32_16x16x32_bf16 v[146:149], v[6:9], v[50:53], v[146:149]
    ds_read_b64 v[72:73], v2 offset:72
    v_mfma_f32_16x16x32_bf16 v[142:145], v[6:9], v[46:49], v[142:145]
    ds_read_b128 v[118:121], v3 offset:2432
    v_mfma_f32_16x16x32_bf16 v[138:141], v[6:9], v[42:45], v[138:141]
    ds_read_b128 v[114:117], v3 offset:1920
    v_mfma_f32_16x16x32_bf16 v[134:137], v[6:9], v[38:41], v[134:137]
    ds_read_b128 v[110:113], v3 offset:1408
    v_mfma_f32_16x16x32_bf16 v[154:157], v[10:13], v[54:57], v[154:157]
    ds_read_b128 v[106:109], v3 offset:896
    v_mfma_f32_16x16x32_bf16 v[150:153], v[10:13], v[50:53], v[150:153]
    ds_read_b128 v[102:105], v3 offset:384
    v_mfma_f32_16x16x32_bf16 v[146:149], v[10:13], v[46:49], v[146:149]
    ds_read_b64 v[74:75], v2 offset:576
    v_mfma_f32_16x16x32_bf16 v[142:145], v[10:13], v[42:45], v[142:145]
    ds_read_b64 v[76:77], v2 offset:584
    v_mfma_f32_16x16x32_bf16 v[138:141], v[10:13], v[38:41], v[138:141]
    ds_read_b64 v[78:79], v2 offset:1088
    v_mfma_f32_16x16x32_bf16 v[154:157], v[14:17], v[50:53], v[154:157]
    ds_read_b64 v[80:81], v2 offset:1096
    v_mfma_f32_16x16x32_bf16 v[150:153], v[14:17], v[46:49], v[150:153]
    ds_read_b64 v[82:83], v2 offset:1600
    v_mfma_f32_16x16x32_bf16 v[146:149], v[14:17], v[42:45], v[146:149]
    ds_read_b64 v[84:85], v2 offset:1608
    v_mfma_f32_16x16x32_bf16 v[142:145], v[14:17], v[38:41], v[142:145]
    ds_read_b64 v[86:87], v2 offset:2112
    v_mfma_f32_16x16x32_bf16 v[154:157], v[18:21], v[46:49], v[154:157]
    ds_read_b64 v[88:89], v2 offset:2120
    v_mfma_f32_16x16x32_bf16 v[150:153], v[18:21], v[42:45], v[150:153]
    ds_read_b64 v[90:91], v2 offset:2624
    v_mfma_f32_16x16x32_bf16 v[146:149], v[18:21], v[38:41], v[146:149]
    ds_read_b64 v[92:93], v2 offset:2632
    v_mfma_f32_16x16x32_bf16 v[154:157], v[22:25], v[42:45], v[154:157]
    v_mfma_f32_16x16x32_bf16 v[150:153], v[22:25], v[38:41], v[150:153]
    v_mfma_f32_16x16x32_bf16 v[154:157], v[26:29], v[38:41], v[154:157]
    s_waitcnt lgkmcnt(10)
    v_mfma_f32_16x16x32_bf16 v[154:157], v[70:73], v[122:125], v[154:157]
    ds_read_b128 v[58:61], v3 offset:2880
    v_mfma_f32_16x16x32_bf16 v[150:153], v[70:73], v[118:121], v[150:153]
    ds_read_b64 v[6:7], v2 offset:128
    v_mfma_f32_16x16x32_bf16 v[146:149], v[70:73], v[114:117], v[146:149]
    ds_read_b64 v[8:9], v2 offset:136
    v_mfma_f32_16x16x32_bf16 v[142:145], v[70:73], v[110:113], v[142:145]
    ds_read_b128 v[54:57], v3 offset:2368
    v_mfma_f32_16x16x32_bf16 v[138:141], v[70:73], v[106:109], v[138:141]
    ds_read_b128 v[50:53], v3 offset:1856
    v_mfma_f32_16x16x32_bf16 v[134:137], v[70:73], v[102:105], v[134:137]
    ds_read_b128 v[46:49], v3 offset:1344
    s_waitcnt lgkmcnt(12)
    v_mfma_f32_16x16x32_bf16 v[154:157], v[74:77], v[118:121], v[154:157]
    ds_read_b128 v[42:45], v3 offset:832
    v_mfma_f32_16x16x32_bf16 v[150:153], v[74:77], v[114:117], v[150:153]
    ds_read_b128 v[38:41], v3 offset:320
    v_mfma_f32_16x16x32_bf16 v[146:149], v[74:77], v[110:113], v[146:149]
    ds_read_b64 v[10:11], v2 offset:640
    v_mfma_f32_16x16x32_bf16 v[142:145], v[74:77], v[106:109], v[142:145]
    ds_read_b64 v[12:13], v2 offset:648
    v_mfma_f32_16x16x32_bf16 v[138:141], v[74:77], v[102:105], v[138:141]
    ds_read_b64 v[14:15], v2 offset:1152
    v_mfma_f32_16x16x32_bf16 v[154:157], v[78:81], v[114:117], v[154:157]
    ds_read_b64 v[16:17], v2 offset:1160
    v_mfma_f32_16x16x32_bf16 v[150:153], v[78:81], v[110:113], v[150:153]
    ds_read_b64 v[18:19], v2 offset:1664
    v_mfma_f32_16x16x32_bf16 v[146:149], v[78:81], v[106:109], v[146:149]
    ds_read_b64 v[20:21], v2 offset:1672
    v_mfma_f32_16x16x32_bf16 v[142:145], v[78:81], v[102:105], v[142:145]
    ds_read_b64 v[22:23], v2 offset:2176
    s_waitcnt lgkmcnt(12)
    v_mfma_f32_16x16x32_bf16 v[154:157], v[82:85], v[110:113], v[154:157]
    ds_read_b64 v[24:25], v2 offset:2184
    v_mfma_f32_16x16x32_bf16 v[150:153], v[82:85], v[106:109], v[150:153]
    ds_read_b64 v[26:27], v2 offset:2688
    v_mfma_f32_16x16x32_bf16 v[146:149], v[82:85], v[102:105], v[146:149]
    ds_read_b64 v[28:29], v2 offset:2696
    v_mfma_f32_16x16x32_bf16 v[154:157], v[86:89], v[106:109], v[154:157]
    v_mfma_f32_16x16x32_bf16 v[150:153], v[86:89], v[102:105], v[150:153]
    v_mfma_f32_16x16x32_bf16 v[154:157], v[90:93], v[102:105], v[154:157]
    v_mfma_f32_16x16x32_bf16 v[154:157], v[6:9], v[58:61], v[154:157]
    ds_read_b128 v[122:125], v3 offset:2816
    s_waitcnt lgkmcnt(9)
    v_mfma_f32_16x16x32_bf16 v[150:153], v[6:9], v[54:57], v[150:153]
    ds_read_b64 v[70:71], v2 offset:192
    v_mfma_f32_16x16x32_bf16 v[146:149], v[6:9], v[50:53], v[146:149]
    ds_read_b64 v[72:73], v2 offset:200
    v_mfma_f32_16x16x32_bf16 v[142:145], v[6:9], v[46:49], v[142:145]
    ds_read_b128 v[118:121], v3 offset:2304
    v_mfma_f32_16x16x32_bf16 v[138:141], v[6:9], v[42:45], v[138:141]
    ds_read_b128 v[114:117], v3 offset:1792
    v_mfma_f32_16x16x32_bf16 v[134:137], v[6:9], v[38:41], v[134:137]
    ds_read_b128 v[110:113], v3 offset:1280
    v_mfma_f32_16x16x32_bf16 v[154:157], v[10:13], v[54:57], v[154:157]
    ds_read_b128 v[106:109], v3 offset:768
    v_mfma_f32_16x16x32_bf16 v[150:153], v[10:13], v[50:53], v[150:153]
    ds_read_b128 v[102:105], v3 offset:256
    v_mfma_f32_16x16x32_bf16 v[146:149], v[10:13], v[46:49], v[146:149]
    ds_read_b64 v[74:75], v2 offset:704
    v_mfma_f32_16x16x32_bf16 v[142:145], v[10:13], v[42:45], v[142:145]
    ds_read_b64 v[76:77], v2 offset:712
    v_mfma_f32_16x16x32_bf16 v[138:141], v[10:13], v[38:41], v[138:141]
    ds_read_b64 v[78:79], v2 offset:1216
    s_waitcnt lgkmcnt(12)
    v_mfma_f32_16x16x32_bf16 v[154:157], v[14:17], v[50:53], v[154:157]
    ds_read_b64 v[80:81], v2 offset:1224
    v_mfma_f32_16x16x32_bf16 v[150:153], v[14:17], v[46:49], v[150:153]
    ds_read_b64 v[82:83], v2 offset:1728
    v_mfma_f32_16x16x32_bf16 v[146:149], v[14:17], v[42:45], v[146:149]
    ds_read_b64 v[84:85], v2 offset:1736
    v_mfma_f32_16x16x32_bf16 v[142:145], v[14:17], v[38:41], v[142:145]
    ds_read_b64 v[86:87], v2 offset:2240
    v_mfma_f32_16x16x32_bf16 v[154:157], v[18:21], v[46:49], v[154:157]
    ds_read_b64 v[88:89], v2 offset:2248
    v_mfma_f32_16x16x32_bf16 v[150:153], v[18:21], v[42:45], v[150:153]
    ds_read_b64 v[90:91], v2 offset:2752
    v_mfma_f32_16x16x32_bf16 v[146:149], v[18:21], v[38:41], v[146:149]
    ds_read_b64 v[92:93], v2 offset:2760
    v_mfma_f32_16x16x32_bf16 v[154:157], v[22:25], v[42:45], v[154:157]
    v_mfma_f32_16x16x32_bf16 v[150:153], v[22:25], v[38:41], v[150:153]
    s_waitcnt lgkmcnt(12)
    v_mfma_f32_16x16x32_bf16 v[154:157], v[26:29], v[38:41], v[154:157]
    v_mfma_f32_16x16x32_bf16 v[154:157], v[70:73], v[122:125], v[154:157]
    ds_read_b128 v[58:61], v3 offset:2752
    v_mfma_f32_16x16x32_bf16 v[150:153], v[70:73], v[118:121], v[150:153]
    ds_read_b64 v[6:7], v2 offset:256
    v_mfma_f32_16x16x32_bf16 v[146:149], v[70:73], v[114:117], v[146:149]
    ds_read_b64 v[8:9], v2 offset:264
    v_mfma_f32_16x16x32_bf16 v[142:145], v[70:73], v[110:113], v[142:145]
    ds_read_b128 v[54:57], v3 offset:2240
    s_waitcnt lgkmcnt(12)
    v_mfma_f32_16x16x32_bf16 v[138:141], v[70:73], v[106:109], v[138:141]
    ds_read_b128 v[50:53], v3 offset:1728
    v_mfma_f32_16x16x32_bf16 v[134:137], v[70:73], v[102:105], v[134:137]
    ds_read_b128 v[46:49], v3 offset:1216
    v_mfma_f32_16x16x32_bf16 v[154:157], v[74:77], v[118:121], v[154:157]
    ds_read_b128 v[42:45], v3 offset:704
    v_mfma_f32_16x16x32_bf16 v[150:153], v[74:77], v[114:117], v[150:153]
    ds_read_b128 v[38:41], v3 offset:192
    v_mfma_f32_16x16x32_bf16 v[146:149], v[74:77], v[110:113], v[146:149]
    ds_read_b64 v[10:11], v2 offset:768
    v_mfma_f32_16x16x32_bf16 v[142:145], v[74:77], v[106:109], v[142:145]
    ds_read_b64 v[12:13], v2 offset:776
    v_mfma_f32_16x16x32_bf16 v[138:141], v[74:77], v[102:105], v[138:141]
    ds_read_b64 v[14:15], v2 offset:1280
    s_waitcnt lgkmcnt(12)
    v_mfma_f32_16x16x32_bf16 v[154:157], v[78:81], v[114:117], v[154:157]
    ds_read_b64 v[16:17], v2 offset:1288
    v_mfma_f32_16x16x32_bf16 v[150:153], v[78:81], v[110:113], v[150:153]
    ds_read_b64 v[18:19], v2 offset:1792
    v_mfma_f32_16x16x32_bf16 v[146:149], v[78:81], v[106:109], v[146:149]
    ds_read_b64 v[20:21], v2 offset:1800
    v_mfma_f32_16x16x32_bf16 v[142:145], v[78:81], v[102:105], v[142:145]
    ds_read_b64 v[22:23], v2 offset:2304
    v_mfma_f32_16x16x32_bf16 v[154:157], v[82:85], v[110:113], v[154:157]
    ds_read_b64 v[24:25], v2 offset:2312
    v_mfma_f32_16x16x32_bf16 v[150:153], v[82:85], v[106:109], v[150:153]
    ds_read_b64 v[26:27], v2 offset:2816
    v_mfma_f32_16x16x32_bf16 v[146:149], v[82:85], v[102:105], v[146:149]
    ds_read_b64 v[28:29], v2 offset:2824
    v_mfma_f32_16x16x32_bf16 v[154:157], v[86:89], v[106:109], v[154:157]
    v_mfma_f32_16x16x32_bf16 v[150:153], v[86:89], v[102:105], v[150:153]
    s_waitcnt lgkmcnt(12)
    v_mfma_f32_16x16x32_bf16 v[154:157], v[90:93], v[102:105], v[154:157]
    v_mfma_f32_16x16x32_bf16 v[154:157], v[6:9], v[58:61], v[154:157]
    ds_read_b128 v[122:125], v3 offset:2688
    v_mfma_f32_16x16x32_bf16 v[150:153], v[6:9], v[54:57], v[150:153]
    ds_read_b64 v[70:71], v2 offset:320
    v_mfma_f32_16x16x32_bf16 v[146:149], v[6:9], v[50:53], v[146:149]
    ds_read_b64 v[72:73], v2 offset:328
    v_mfma_f32_16x16x32_bf16 v[142:145], v[6:9], v[46:49], v[142:145]
    ds_read_b128 v[118:121], v3 offset:2176
    s_waitcnt lgkmcnt(12)
    v_mfma_f32_16x16x32_bf16 v[138:141], v[6:9], v[42:45], v[138:141]
    ds_read_b128 v[114:117], v3 offset:1664
    v_mfma_f32_16x16x32_bf16 v[134:137], v[6:9], v[38:41], v[134:137]
    ds_read_b128 v[110:113], v3 offset:1152
    v_mfma_f32_16x16x32_bf16 v[154:157], v[10:13], v[54:57], v[154:157]
    ds_read_b128 v[106:109], v3 offset:640
    v_mfma_f32_16x16x32_bf16 v[150:153], v[10:13], v[50:53], v[150:153]
    ds_read_b128 v[102:105], v3 offset:128
    v_mfma_f32_16x16x32_bf16 v[146:149], v[10:13], v[46:49], v[146:149]
    ds_read_b64 v[74:75], v2 offset:832
    v_mfma_f32_16x16x32_bf16 v[142:145], v[10:13], v[42:45], v[142:145]
    ds_read_b64 v[76:77], v2 offset:840
    v_mfma_f32_16x16x32_bf16 v[138:141], v[10:13], v[38:41], v[138:141]
    ds_read_b64 v[78:79], v2 offset:1344
    s_waitcnt lgkmcnt(12)
    v_mfma_f32_16x16x32_bf16 v[154:157], v[14:17], v[50:53], v[154:157]
    ds_read_b64 v[80:81], v2 offset:1352
    v_mfma_f32_16x16x32_bf16 v[150:153], v[14:17], v[46:49], v[150:153]
    ds_read_b64 v[82:83], v2 offset:1856
    v_mfma_f32_16x16x32_bf16 v[146:149], v[14:17], v[42:45], v[146:149]
    ds_read_b64 v[84:85], v2 offset:1864
    v_mfma_f32_16x16x32_bf16 v[142:145], v[14:17], v[38:41], v[142:145]
    ds_read_b64 v[86:87], v2 offset:2368
    v_mfma_f32_16x16x32_bf16 v[154:157], v[18:21], v[46:49], v[154:157]
    ds_read_b64 v[88:89], v2 offset:2376
    v_mfma_f32_16x16x32_bf16 v[150:153], v[18:21], v[42:45], v[150:153]
    ds_read_b64 v[90:91], v2 offset:2880
    v_mfma_f32_16x16x32_bf16 v[146:149], v[18:21], v[38:41], v[146:149]
    ds_read_b64 v[92:93], v2 offset:2888
    v_mfma_f32_16x16x32_bf16 v[154:157], v[22:25], v[42:45], v[154:157]
    v_mfma_f32_16x16x32_bf16 v[150:153], v[22:25], v[38:41], v[150:153]
    s_waitcnt lgkmcnt(12)
    v_mfma_f32_16x16x32_bf16 v[154:157], v[26:29], v[38:41], v[154:157]
    v_mfma_f32_16x16x32_bf16 v[154:157], v[70:73], v[122:125], v[154:157]
    ds_read_b128 v[58:61], v3 offset:2624
    v_mfma_f32_16x16x32_bf16 v[150:153], v[70:73], v[118:121], v[150:153]
    ds_read_b64 v[6:7], v2 offset:384
    v_mfma_f32_16x16x32_bf16 v[146:149], v[70:73], v[114:117], v[146:149]
    ds_read_b64 v[8:9], v2 offset:392
    v_mfma_f32_16x16x32_bf16 v[142:145], v[70:73], v[110:113], v[142:145]
    ds_read_b128 v[54:57], v3 offset:2112
    s_waitcnt lgkmcnt(12)
    v_mfma_f32_16x16x32_bf16 v[138:141], v[70:73], v[106:109], v[138:141]
    ds_read_b128 v[50:53], v3 offset:1600
    v_mfma_f32_16x16x32_bf16 v[134:137], v[70:73], v[102:105], v[134:137]
    ds_read_b128 v[46:49], v3 offset:1088
    v_mfma_f32_16x16x32_bf16 v[154:157], v[74:77], v[118:121], v[154:157]
    ds_read_b128 v[42:45], v3 offset:576
    v_mfma_f32_16x16x32_bf16 v[150:153], v[74:77], v[114:117], v[150:153]
    ds_read_b128 v[38:41], v3 offset:64
    v_mfma_f32_16x16x32_bf16 v[146:149], v[74:77], v[110:113], v[146:149]
    ds_read_b64 v[10:11], v2 offset:896
    v_mfma_f32_16x16x32_bf16 v[142:145], v[74:77], v[106:109], v[142:145]
    ds_read_b64 v[12:13], v2 offset:904
    v_mfma_f32_16x16x32_bf16 v[138:141], v[74:77], v[102:105], v[138:141]
    ds_read_b64 v[14:15], v2 offset:1408
    s_waitcnt lgkmcnt(12)
    v_mfma_f32_16x16x32_bf16 v[154:157], v[78:81], v[114:117], v[154:157]
    ds_read_b64 v[16:17], v2 offset:1416
    v_mfma_f32_16x16x32_bf16 v[150:153], v[78:81], v[110:113], v[150:153]
    ds_read_b64 v[18:19], v2 offset:1920
    v_mfma_f32_16x16x32_bf16 v[146:149], v[78:81], v[106:109], v[146:149]
    ds_read_b64 v[20:21], v2 offset:1928
    v_mfma_f32_16x16x32_bf16 v[142:145], v[78:81], v[102:105], v[142:145]
    ds_read_b64 v[22:23], v2 offset:2432
    v_mfma_f32_16x16x32_bf16 v[154:157], v[82:85], v[110:113], v[154:157]
    ds_read_b64 v[24:25], v2 offset:2440
    v_mfma_f32_16x16x32_bf16 v[150:153], v[82:85], v[106:109], v[150:153]
    ds_read_b64 v[26:27], v2 offset:2944
    v_mfma_f32_16x16x32_bf16 v[146:149], v[82:85], v[102:105], v[146:149]
    ds_read_b64 v[28:29], v2 offset:2952
    v_mfma_f32_16x16x32_bf16 v[154:157], v[86:89], v[106:109], v[154:157]
    v_mfma_f32_16x16x32_bf16 v[150:153], v[86:89], v[102:105], v[150:153]
    s_waitcnt lgkmcnt(12)
    v_mfma_f32_16x16x32_bf16 v[154:157], v[90:93], v[102:105], v[154:157]
    v_mfma_f32_16x16x32_bf16 v[154:157], v[6:9], v[58:61], v[154:157]
    ds_read_b128 v[122:125], v3 offset:2560
    v_mfma_f32_16x16x32_bf16 v[150:153], v[6:9], v[54:57], v[150:153]
    ds_read_b64 v[70:71], v2 offset:448
    v_mfma_f32_16x16x32_bf16 v[146:149], v[6:9], v[50:53], v[146:149]
    ds_read_b64 v[72:73], v2 offset:456
    v_mfma_f32_16x16x32_bf16 v[142:145], v[6:9], v[46:49], v[142:145]
    ds_read_b128 v[118:121], v3 offset:2048
    s_waitcnt lgkmcnt(12)
    v_mfma_f32_16x16x32_bf16 v[138:141], v[6:9], v[42:45], v[138:141]
    ds_read_b128 v[114:117], v3 offset:1536
    v_mfma_f32_16x16x32_bf16 v[134:137], v[6:9], v[38:41], v[134:137]
    ds_read_b128 v[110:113], v3 offset:1024
    v_mfma_f32_16x16x32_bf16 v[154:157], v[10:13], v[54:57], v[154:157]
    ds_read_b128 v[106:109], v3 offset:512
    v_mfma_f32_16x16x32_bf16 v[150:153], v[10:13], v[50:53], v[150:153]
    ds_read_b128 v[102:105], v3 offset:0
    v_mfma_f32_16x16x32_bf16 v[146:149], v[10:13], v[46:49], v[146:149]
    ds_read_b64 v[74:75], v2 offset:960
    v_mfma_f32_16x16x32_bf16 v[142:145], v[10:13], v[42:45], v[142:145]
    ds_read_b64 v[76:77], v2 offset:968
    v_mfma_f32_16x16x32_bf16 v[138:141], v[10:13], v[38:41], v[138:141]
    ds_read_b64 v[78:79], v2 offset:1472
    s_waitcnt lgkmcnt(12)
    v_mfma_f32_16x16x32_bf16 v[154:157], v[14:17], v[50:53], v[154:157]
    ds_read_b64 v[80:81], v2 offset:1480
    v_mfma_f32_16x16x32_bf16 v[150:153], v[14:17], v[46:49], v[150:153]
    ds_read_b64 v[82:83], v2 offset:1984
    v_mfma_f32_16x16x32_bf16 v[146:149], v[14:17], v[42:45], v[146:149]
    ds_read_b64 v[84:85], v2 offset:1992
    v_mfma_f32_16x16x32_bf16 v[142:145], v[14:17], v[38:41], v[142:145]
    ds_read_b64 v[86:87], v2 offset:2496
    v_mfma_f32_16x16x32_bf16 v[154:157], v[18:21], v[46:49], v[154:157]
    ds_read_b64 v[88:89], v2 offset:2504
    v_mfma_f32_16x16x32_bf16 v[150:153], v[18:21], v[42:45], v[150:153]
    ds_read_b64 v[90:91], v2 offset:3008
    v_mfma_f32_16x16x32_bf16 v[146:149], v[18:21], v[38:41], v[146:149]
    ds_read_b64 v[92:93], v2 offset:3016
    v_mfma_f32_16x16x32_bf16 v[154:157], v[22:25], v[42:45], v[154:157]
    v_mfma_f32_16x16x32_bf16 v[150:153], v[22:25], v[38:41], v[150:153]
    s_waitcnt lgkmcnt(12)
    v_mfma_f32_16x16x32_bf16 v[154:157], v[26:29], v[38:41], v[154:157]
    v_mfma_f32_16x16x32_bf16 v[154:157], v[70:73], v[122:125], v[154:157]
    ds_read_b128 v[66:69], v3 offset:4032
    ds_read_b64 v[6:7], v2 offset:0
    v_mfma_f32_16x16x32_bf16 v[150:153], v[70:73], v[118:121], v[150:153]
    ds_read_b64 v[8:9], v2 offset:8
    v_mfma_f32_16x16x32_bf16 v[146:149], v[70:73], v[114:117], v[146:149]
    ds_read_b128 v[62:65], v3 offset:3520
    v_mfma_f32_16x16x32_bf16 v[142:145], v[70:73], v[110:113], v[142:145]
    ds_read_b64 v[10:11], v2 offset:512
    ds_read_b64 v[12:13], v2 offset:520
    s_waitcnt lgkmcnt(12)
    v_mfma_f32_16x16x32_bf16 v[138:141], v[70:73], v[106:109], v[138:141]
    ds_read_b128 v[58:61], v3 offset:3008
    v_mfma_f32_16x16x32_bf16 v[134:137], v[70:73], v[102:105], v[134:137]
    ds_read_b64 v[14:15], v2 offset:1024
    v_mfma_f32_16x16x32_bf16 v[154:157], v[74:77], v[118:121], v[154:157]
    ds_read_b64 v[16:17], v2 offset:1032
    v_mfma_f32_16x16x32_bf16 v[150:153], v[74:77], v[114:117], v[150:153]
    ds_read_b128 v[54:57], v3 offset:2496
    ds_read_b64 v[18:19], v2 offset:1536
    v_mfma_f32_16x16x32_bf16 v[146:149], v[74:77], v[110:113], v[146:149]
    ds_read_b64 v[20:21], v2 offset:1544
    v_mfma_f32_16x16x32_bf16 v[142:145], v[74:77], v[106:109], v[142:145]
    ds_read_b128 v[50:53], v3 offset:1984
    v_mfma_f32_16x16x32_bf16 v[138:141], v[74:77], v[102:105], v[138:141]
    ds_read_b64 v[22:23], v2 offset:2048
    v_mfma_f32_16x16x32_bf16 v[154:157], v[78:81], v[114:117], v[154:157]
    ds_read_b64 v[24:25], v2 offset:2056
    ds_read_b128 v[46:49], v3 offset:1472
    v_mfma_f32_16x16x32_bf16 v[150:153], v[78:81], v[110:113], v[150:153]
    ds_read_b64 v[26:27], v2 offset:2560
    v_mfma_f32_16x16x32_bf16 v[146:149], v[78:81], v[106:109], v[146:149]
    ds_read_b64 v[28:29], v2 offset:2568
    v_mfma_f32_16x16x32_bf16 v[142:145], v[78:81], v[102:105], v[142:145]
    ds_read_b128 v[42:45], v3 offset:960
    s_waitcnt lgkmcnt(12)
    v_mfma_f32_16x16x32_bf16 v[154:157], v[82:85], v[110:113], v[154:157]
    ds_read_b64 v[30:31], v2 offset:3072
    ds_read_b64 v[32:33], v2 offset:3080
    v_mfma_f32_16x16x32_bf16 v[150:153], v[82:85], v[106:109], v[150:153]
    ds_read_b128 v[38:41], v3 offset:448
    v_mfma_f32_16x16x32_bf16 v[146:149], v[82:85], v[102:105], v[146:149]
    ds_read_b64 v[34:35], v2 offset:3584
    v_mfma_f32_16x16x32_bf16 v[154:157], v[86:89], v[106:109], v[154:157]
    ds_read_b64 v[36:37], v2 offset:3592
    v_mfma_f32_16x16x32_bf16 v[150:153], v[86:89], v[102:105], v[150:153]
    v_mfma_f32_16x16x32_bf16 v[154:157], v[90:93], v[102:105], v[154:157]
    v_mfma_f32_16x16x32_bf16 v[162:165], v[6:9], v[66:69], v[162:165]
    ds_read_b128 v[130:133], v3 offset:3968
    ds_read_b64 v[70:71], v2 offset:64
    v_mfma_f32_16x16x32_bf16 v[158:161], v[6:9], v[62:65], v[158:161]
    ds_read_b64 v[72:73], v2 offset:72
    ds_read_b128 v[126:129], v3 offset:3456
    v_mfma_f32_16x16x32_bf16 v[162:165], v[10:13], v[62:65], v[162:165]
    ds_read_b64 v[74:75], v2 offset:576
    ds_read_b64 v[76:77], v2 offset:584
    v_cvt_pk_bf16_f32 v134, v134, v135
    v_cvt_pk_bf16_f32 v135, v136, v137
    v_mfma_f32_16x16x32_bf16 v[158:161], v[10:13], v[58:61], v[158:161]
    ds_read_b128 v[122:125], v3 offset:2944
    ds_read_b64 v[78:79], v2 offset:1088
    v_cvt_pk_bf16_f32 v136, v138, v139
    v_cvt_pk_bf16_f32 v137, v140, v141
    s_waitcnt lgkmcnt(12)
    v_mfma_f32_16x16x32_bf16 v[162:165], v[14:17], v[58:61], v[162:165]
    ds_read_b64 v[80:81], v2 offset:1096
    ds_read_b128 v[118:121], v3 offset:2432
    v_cvt_pk_bf16_f32 v142, v142, v143
    v_mfma_f32_16x16x32_bf16 v[158:161], v[14:17], v[54:57], v[158:161]
    ds_read_b64 v[82:83], v2 offset:1600
    ds_read_b64 v[84:85], v2 offset:1608
    v_cvt_pk_bf16_f32 v143, v144, v145
    v_cvt_pk_bf16_f32 v144, v146, v147
    v_mfma_f32_16x16x32_bf16 v[162:165], v[18:21], v[54:57], v[162:165]
    ds_read_b128 v[114:117], v3 offset:1920
    v_cvt_pk_bf16_f32 v145, v148, v149
    v_cvt_pk_bf16_f32 v150, v150, v151
    v_mfma_f32_16x16x32_bf16 v[158:161], v[18:21], v[50:53], v[158:161]
    ds_read_b64 v[86:87], v2 offset:2112
    ds_read_b64 v[88:89], v2 offset:2120
    v_cvt_pk_bf16_f32 v151, v152, v153
    v_mfma_f32_16x16x32_bf16 v[162:165], v[22:25], v[50:53], v[162:165]
    ds_read_b128 v[110:113], v3 offset:1408
    ds_read_b64 v[90:91], v2 offset:2624
    v_cvt_pk_bf16_f32 v152, v154, v155
    v_cvt_pk_bf16_f32 v153, v156, v157
    v_mfma_f32_16x16x32_bf16 v[158:161], v[22:25], v[46:49], v[158:161]
    ds_read_b64 v[92:93], v2 offset:2632
    ds_read_b128 v[106:109], v3 offset:896
    v_permlane16_swap_b32 v134, v136
    v_mfma_f32_16x16x32_bf16 v[162:165], v[26:29], v[46:49], v[162:165]
    ds_read_b64 v[94:95], v2 offset:3136
    ds_read_b64 v[96:97], v2 offset:3144
    v_permlane16_swap_b32 v135, v137
    v_permlane16_swap_b32 v142, v144
    v_mfma_f32_16x16x32_bf16 v[158:161], v[26:29], v[42:45], v[158:161]
    ds_read_b128 v[102:105], v3 offset:384
    ds_read_b64 v[98:99], v2 offset:3648
    v_permlane16_swap_b32 v143, v145
    v_permlane16_swap_b32 v150, v152
    s_waitcnt lgkmcnt(12)
    v_mfma_f32_16x16x32_bf16 v[162:165], v[30:33], v[42:45], v[162:165]
    ds_read_b64 v[100:101], v2 offset:3656
    v_permlane16_swap_b32 v151, v153
    v_mfma_f32_16x16x32_bf16 v[158:161], v[30:33], v[38:41], v[158:161]
    ds_write_b128 v4, v[134:137] offset:0
    ds_write_b128 v4, v[142:145] offset:1024
    v_mfma_f32_16x16x32_bf16 v[162:165], v[34:37], v[38:41], v[162:165]
    ds_write_b128 v4, v[150:153] offset:2048
    v_mfma_f32_16x16x32_bf16 v[162:165], v[70:73], v[130:133], v[162:165]
    ds_read_b128 v[66:69], v3 offset:3904
    ds_read_b64 v[6:7], v2 offset:128
    v_mfma_f32_16x16x32_bf16 v[158:161], v[70:73], v[126:129], v[158:161]
    ds_read_b64 v[8:9], v2 offset:136
    ds_read_b128 v[62:65], v3 offset:3392
    v_mfma_f32_16x16x32_bf16 v[162:165], v[74:77], v[126:129], v[162:165]
    ds_read_b64 v[10:11], v2 offset:640
    ds_read_b64 v[12:13], v2 offset:648
    s_waitcnt lgkmcnt(6)
    s_barrier
    v_mfma_f32_16x16x32_bf16 v[158:161], v[74:77], v[122:125], v[158:161]
    ds_read_b128 v[58:61], v3 offset:2880
    ds_read_b64 v[14:15], v2 offset:1152
    v_mfma_f32_16x16x32_bf16 v[162:165], v[78:81], v[122:125], v[162:165]
    ds_read_b64 v[16:17], v2 offset:1160
    ds_read_b128 v[54:57], v3 offset:2368
    v_mfma_f32_16x16x32_bf16 v[158:161], v[78:81], v[118:121], v[158:161]
    ds_read_b64 v[18:19], v2 offset:1664
    ds_read_b64 v[20:21], v2 offset:1672
    v_mfma_f32_16x16x32_bf16 v[162:165], v[82:85], v[118:121], v[162:165]
    ds_read_b128 v[50:53], v3 offset:1856
    v_mfma_f32_16x16x32_bf16 v[158:161], v[82:85], v[114:117], v[158:161]
    ds_read_b64 v[22:23], v2 offset:2176
    ds_read_b64 v[24:25], v2 offset:2184
    v_mfma_f32_16x16x32_bf16 v[162:165], v[86:89], v[114:117], v[162:165]
    ds_read_b128 v[46:49], v3 offset:1344
    ds_read_b64 v[26:27], v2 offset:2688
    v_mfma_f32_16x16x32_bf16 v[158:161], v[86:89], v[110:113], v[158:161]
    ds_read_b64 v[28:29], v2 offset:2696
    ds_read_b128 v[42:45], v3 offset:832
    v_mfma_f32_16x16x32_bf16 v[162:165], v[90:93], v[110:113], v[162:165]
    ds_read_b64 v[30:31], v2 offset:3200
    ds_read_b64 v[32:33], v2 offset:3208
    v_mfma_f32_16x16x32_bf16 v[158:161], v[90:93], v[106:109], v[158:161]
    ds_read_b128 v[38:41], v3 offset:320
    ds_read_b64 v[34:35], v2 offset:3712
    v_mfma_f32_16x16x32_bf16 v[162:165], v[94:97], v[106:109], v[162:165]
    ds_read_b64 v[36:37], v2 offset:3720
    v_mfma_f32_16x16x32_bf16 v[158:161], v[94:97], v[102:105], v[158:161]
    v_mfma_f32_16x16x32_bf16 v[162:165], v[98:101], v[102:105], v[162:165]
    s_waitcnt lgkmcnt(12)
    v_mfma_f32_16x16x32_bf16 v[162:165], v[6:9], v[66:69], v[162:165]
    ds_read_b128 v[130:133], v3 offset:3840
    ds_read_b64 v[70:71], v2 offset:192
    v_mfma_f32_16x16x32_bf16 v[158:161], v[6:9], v[62:65], v[158:161]
    ds_read_b64 v[72:73], v2 offset:200
    ds_read_b128 v[126:129], v3 offset:3328
    v_mfma_f32_16x16x32_bf16 v[162:165], v[10:13], v[62:65], v[162:165]
    ds_read_b64 v[74:75], v2 offset:704
    ds_read_b64 v[76:77], v2 offset:712
    v_mfma_f32_16x16x32_bf16 v[158:161], v[10:13], v[58:61], v[158:161]
    ds_read_b128 v[122:125], v3 offset:2816
    ds_read_b64 v[78:79], v2 offset:1216
    v_mfma_f32_16x16x32_bf16 v[162:165], v[14:17], v[58:61], v[162:165]
    ds_read_b64 v[80:81], v2 offset:1224
    ds_read_b128 v[118:121], v3 offset:2304
    v_mfma_f32_16x16x32_bf16 v[158:161], v[14:17], v[54:57], v[158:161]
    ds_read_b64 v[82:83], v2 offset:1728
    ds_read_b64 v[84:85], v2 offset:1736
    v_mfma_f32_16x16x32_bf16 v[162:165], v[18:21], v[54:57], v[162:165]
    ds_read_b128 v[114:117], v3 offset:1792
    s_waitcnt lgkmcnt(12)
    v_mfma_f32_16x16x32_bf16 v[158:161], v[18:21], v[50:53], v[158:161]
    ds_read_b64 v[86:87], v2 offset:2240
    ds_read_b64 v[88:89], v2 offset:2248
    v_mfma_f32_16x16x32_bf16 v[162:165], v[22:25], v[50:53], v[162:165]
    ds_read_b128 v[110:113], v3 offset:1280
    ds_read_b64 v[90:91], v2 offset:2752
    v_mfma_f32_16x16x32_bf16 v[158:161], v[22:25], v[46:49], v[158:161]
    ds_read_b64 v[92:93], v2 offset:2760
    ds_read_b128 v[106:109], v3 offset:768
    v_mfma_f32_16x16x32_bf16 v[162:165], v[26:29], v[46:49], v[162:165]
    ds_read_b64 v[94:95], v2 offset:3264
    ds_read_b64 v[96:97], v2 offset:3272
    v_mfma_f32_16x16x32_bf16 v[158:161], v[26:29], v[42:45], v[158:161]
    ds_read_b128 v[102:105], v3 offset:256
    ds_read_b64 v[98:99], v2 offset:3776
    v_mfma_f32_16x16x32_bf16 v[162:165], v[30:33], v[42:45], v[162:165]
    ds_read_b64 v[100:101], v2 offset:3784
    v_mfma_f32_16x16x32_bf16 v[158:161], v[30:33], v[38:41], v[158:161]
    v_mfma_f32_16x16x32_bf16 v[162:165], v[34:37], v[38:41], v[162:165]
    s_waitcnt lgkmcnt(12)
    v_mfma_f32_16x16x32_bf16 v[162:165], v[70:73], v[130:133], v[162:165]
    ds_read_b128 v[66:69], v3 offset:3776
    ds_read_b64 v[6:7], v2 offset:256
    v_mfma_f32_16x16x32_bf16 v[158:161], v[70:73], v[126:129], v[158:161]
    ds_read_b64 v[8:9], v2 offset:264
    ds_read_b128 v[62:65], v3 offset:3264
    v_mfma_f32_16x16x32_bf16 v[162:165], v[74:77], v[126:129], v[162:165]
    ds_read_b64 v[10:11], v2 offset:768
    ds_read_b64 v[12:13], v2 offset:776
    v_mfma_f32_16x16x32_bf16 v[158:161], v[74:77], v[122:125], v[158:161]
    ds_read_b128 v[58:61], v3 offset:2752
    ds_read_b64 v[14:15], v2 offset:1280
    v_mfma_f32_16x16x32_bf16 v[162:165], v[78:81], v[122:125], v[162:165]
    ds_read_b64 v[16:17], v2 offset:1288
    ds_read_b128 v[54:57], v3 offset:2240
    v_mfma_f32_16x16x32_bf16 v[158:161], v[78:81], v[118:121], v[158:161]
    ds_read_b64 v[18:19], v2 offset:1792
    ds_read_b64 v[20:21], v2 offset:1800
    v_mfma_f32_16x16x32_bf16 v[162:165], v[82:85], v[118:121], v[162:165]
    ds_read_b128 v[50:53], v3 offset:1728
    s_waitcnt lgkmcnt(12)
    v_mfma_f32_16x16x32_bf16 v[158:161], v[82:85], v[114:117], v[158:161]
    ds_read_b64 v[22:23], v2 offset:2304
    ds_read_b64 v[24:25], v2 offset:2312
    v_mfma_f32_16x16x32_bf16 v[162:165], v[86:89], v[114:117], v[162:165]
    ds_read_b128 v[46:49], v3 offset:1216
    ds_read_b64 v[26:27], v2 offset:2816
    v_mfma_f32_16x16x32_bf16 v[158:161], v[86:89], v[110:113], v[158:161]
    ds_read_b64 v[28:29], v2 offset:2824
    ds_read_b128 v[42:45], v3 offset:704
    v_mfma_f32_16x16x32_bf16 v[162:165], v[90:93], v[110:113], v[162:165]
    ds_read_b64 v[30:31], v2 offset:3328
    ds_read_b64 v[32:33], v2 offset:3336
    v_mfma_f32_16x16x32_bf16 v[158:161], v[90:93], v[106:109], v[158:161]
    ds_read_b128 v[38:41], v3 offset:192
    ds_read_b64 v[34:35], v2 offset:3840
    v_mfma_f32_16x16x32_bf16 v[162:165], v[94:97], v[106:109], v[162:165]
    ds_read_b64 v[36:37], v2 offset:3848
    v_mfma_f32_16x16x32_bf16 v[158:161], v[94:97], v[102:105], v[158:161]
    v_mfma_f32_16x16x32_bf16 v[162:165], v[98:101], v[102:105], v[162:165]
    s_waitcnt lgkmcnt(12)
    v_mfma_f32_16x16x32_bf16 v[162:165], v[6:9], v[66:69], v[162:165]
    ds_read_b128 v[130:133], v3 offset:3712
    ds_read_b64 v[70:71], v2 offset:320
    v_mfma_f32_16x16x32_bf16 v[158:161], v[6:9], v[62:65], v[158:161]
    ds_read_b64 v[72:73], v2 offset:328
    ds_read_b128 v[126:129], v3 offset:3200
    v_mfma_f32_16x16x32_bf16 v[162:165], v[10:13], v[62:65], v[162:165]
    ds_read_b64 v[74:75], v2 offset:832
    ds_read_b64 v[76:77], v2 offset:840
    v_mfma_f32_16x16x32_bf16 v[158:161], v[10:13], v[58:61], v[158:161]
    ds_read_b128 v[122:125], v3 offset:2688
    ds_read_b64 v[78:79], v2 offset:1344
    v_mfma_f32_16x16x32_bf16 v[162:165], v[14:17], v[58:61], v[162:165]
    ds_read_b64 v[80:81], v2 offset:1352
    ds_read_b128 v[118:121], v3 offset:2176
    v_mfma_f32_16x16x32_bf16 v[158:161], v[14:17], v[54:57], v[158:161]
    ds_read_b64 v[82:83], v2 offset:1856
    ds_read_b64 v[84:85], v2 offset:1864
    v_mfma_f32_16x16x32_bf16 v[162:165], v[18:21], v[54:57], v[162:165]
    ds_read_b128 v[114:117], v3 offset:1664
    s_waitcnt lgkmcnt(12)
    v_mfma_f32_16x16x32_bf16 v[158:161], v[18:21], v[50:53], v[158:161]
    ds_read_b64 v[86:87], v2 offset:2368
    ds_read_b64 v[88:89], v2 offset:2376
    v_mfma_f32_16x16x32_bf16 v[162:165], v[22:25], v[50:53], v[162:165]
    ds_read_b128 v[110:113], v3 offset:1152
    ds_read_b64 v[90:91], v2 offset:2880
    v_mfma_f32_16x16x32_bf16 v[158:161], v[22:25], v[46:49], v[158:161]
    ds_read_b64 v[92:93], v2 offset:2888
    ds_read_b128 v[106:109], v3 offset:640
    v_mfma_f32_16x16x32_bf16 v[162:165], v[26:29], v[46:49], v[162:165]
    ds_read_b64 v[94:95], v2 offset:3392
    ds_read_b64 v[96:97], v2 offset:3400
    v_mfma_f32_16x16x32_bf16 v[158:161], v[26:29], v[42:45], v[158:161]
    ds_read_b128 v[102:105], v3 offset:128
    ds_read_b64 v[98:99], v2 offset:3904
    v_mfma_f32_16x16x32_bf16 v[162:165], v[30:33], v[42:45], v[162:165]
    ds_read_b64 v[100:101], v2 offset:3912
    v_mfma_f32_16x16x32_bf16 v[158:161], v[30:33], v[38:41], v[158:161]
    v_mfma_f32_16x16x32_bf16 v[162:165], v[34:37], v[38:41], v[162:165]
    s_waitcnt lgkmcnt(12)
    v_mfma_f32_16x16x32_bf16 v[162:165], v[70:73], v[130:133], v[162:165]
    ds_read_b128 v[66:69], v3 offset:3648
    ds_read_b64 v[6:7], v2 offset:384
    v_mfma_f32_16x16x32_bf16 v[158:161], v[70:73], v[126:129], v[158:161]
    ds_read_b64 v[8:9], v2 offset:392
    ds_read_b128 v[62:65], v3 offset:3136
    v_mfma_f32_16x16x32_bf16 v[162:165], v[74:77], v[126:129], v[162:165]
    ds_read_b64 v[10:11], v2 offset:896
    ds_read_b64 v[12:13], v2 offset:904
    v_mfma_f32_16x16x32_bf16 v[158:161], v[74:77], v[122:125], v[158:161]
    ds_read_b128 v[58:61], v3 offset:2624
    ds_read_b64 v[14:15], v2 offset:1408
    v_mfma_f32_16x16x32_bf16 v[162:165], v[78:81], v[122:125], v[162:165]
    ds_read_b64 v[16:17], v2 offset:1416
    ds_read_b128 v[54:57], v3 offset:2112
    v_mfma_f32_16x16x32_bf16 v[158:161], v[78:81], v[118:121], v[158:161]
    ds_read_b64 v[18:19], v2 offset:1920
    ds_read_b64 v[20:21], v2 offset:1928
    v_mfma_f32_16x16x32_bf16 v[162:165], v[82:85], v[118:121], v[162:165]
    ds_read_b128 v[50:53], v3 offset:1600
    s_waitcnt lgkmcnt(12)
    v_mfma_f32_16x16x32_bf16 v[158:161], v[82:85], v[114:117], v[158:161]
    ds_read_b64 v[22:23], v2 offset:2432
    ds_read_b64 v[24:25], v2 offset:2440
    v_mfma_f32_16x16x32_bf16 v[162:165], v[86:89], v[114:117], v[162:165]
    ds_read_b128 v[46:49], v3 offset:1088
    ds_read_b64 v[26:27], v2 offset:2944
    v_mfma_f32_16x16x32_bf16 v[158:161], v[86:89], v[110:113], v[158:161]
    ds_read_b64 v[28:29], v2 offset:2952
    ds_read_b128 v[42:45], v3 offset:576
    v_mfma_f32_16x16x32_bf16 v[162:165], v[90:93], v[110:113], v[162:165]
    ds_read_b64 v[30:31], v2 offset:3456
    ds_read_b64 v[32:33], v2 offset:3464
    v_mfma_f32_16x16x32_bf16 v[158:161], v[90:93], v[106:109], v[158:161]
    ds_read_b128 v[38:41], v3 offset:64
    ds_read_b64 v[34:35], v2 offset:3968
    v_mfma_f32_16x16x32_bf16 v[162:165], v[94:97], v[106:109], v[162:165]
    ds_read_b64 v[36:37], v2 offset:3976
    v_mfma_f32_16x16x32_bf16 v[158:161], v[94:97], v[102:105], v[158:161]
    v_mfma_f32_16x16x32_bf16 v[162:165], v[98:101], v[102:105], v[162:165]
    s_waitcnt lgkmcnt(12)
    v_mfma_f32_16x16x32_bf16 v[162:165], v[6:9], v[66:69], v[162:165]
    ds_read_b128 v[130:133], v3 offset:3584
    ds_read_b64 v[70:71], v2 offset:448
    v_mfma_f32_16x16x32_bf16 v[158:161], v[6:9], v[62:65], v[158:161]
    ds_read_b64 v[72:73], v2 offset:456
    ds_read_b128 v[126:129], v3 offset:3072
    v_mfma_f32_16x16x32_bf16 v[162:165], v[10:13], v[62:65], v[162:165]
    ds_read_b64 v[74:75], v2 offset:960
    ds_read_b64 v[76:77], v2 offset:968
    v_mfma_f32_16x16x32_bf16 v[158:161], v[10:13], v[58:61], v[158:161]
    ds_read_b128 v[122:125], v3 offset:2560
    ds_read_b64 v[78:79], v2 offset:1472
    v_mfma_f32_16x16x32_bf16 v[162:165], v[14:17], v[58:61], v[162:165]
    ds_read_b64 v[80:81], v2 offset:1480
    ds_read_b128 v[118:121], v3 offset:2048
    v_mfma_f32_16x16x32_bf16 v[158:161], v[14:17], v[54:57], v[158:161]
    ds_read_b64 v[82:83], v2 offset:1984
    ds_read_b64 v[84:85], v2 offset:1992
    v_mfma_f32_16x16x32_bf16 v[162:165], v[18:21], v[54:57], v[162:165]
    ds_read_b128 v[114:117], v3 offset:1536
    s_waitcnt lgkmcnt(12)
    v_mfma_f32_16x16x32_bf16 v[158:161], v[18:21], v[50:53], v[158:161]
    ds_read_b64 v[86:87], v2 offset:2496
    ds_read_b64 v[88:89], v2 offset:2504
    v_mfma_f32_16x16x32_bf16 v[162:165], v[22:25], v[50:53], v[162:165]
    ds_read_b128 v[110:113], v3 offset:1024
    ds_read_b64 v[90:91], v2 offset:3008
    v_mfma_f32_16x16x32_bf16 v[158:161], v[22:25], v[46:49], v[158:161]
    ds_read_b64 v[92:93], v2 offset:3016
    ds_read_b128 v[106:109], v3 offset:512
    v_mfma_f32_16x16x32_bf16 v[162:165], v[26:29], v[46:49], v[162:165]
    ds_read_b64 v[94:95], v2 offset:3520
    ds_read_b64 v[96:97], v2 offset:3528
    v_mfma_f32_16x16x32_bf16 v[158:161], v[26:29], v[42:45], v[158:161]
    ds_read_b128 v[102:105], v3 offset:0
    ds_read_b64 v[98:99], v2 offset:4032
    v_mfma_f32_16x16x32_bf16 v[162:165], v[30:33], v[42:45], v[162:165]
    ds_read_b64 v[100:101], v2 offset:4040
    v_mfma_f32_16x16x32_bf16 v[158:161], v[30:33], v[38:41], v[158:161]
    v_mfma_f32_16x16x32_bf16 v[162:165], v[34:37], v[38:41], v[162:165]
    s_waitcnt lgkmcnt(12)
    v_mfma_f32_16x16x32_bf16 v[162:165], v[70:73], v[130:133], v[162:165]
    v_mfma_f32_16x16x32_bf16 v[158:161], v[70:73], v[126:129], v[158:161]
    v_mfma_f32_16x16x32_bf16 v[162:165], v[74:77], v[126:129], v[162:165]
    v_mfma_f32_16x16x32_bf16 v[158:161], v[74:77], v[122:125], v[158:161]
    v_mfma_f32_16x16x32_bf16 v[162:165], v[78:81], v[122:125], v[162:165]
    v_mfma_f32_16x16x32_bf16 v[158:161], v[78:81], v[118:121], v[158:161]
    v_mfma_f32_16x16x32_bf16 v[162:165], v[82:85], v[118:121], v[162:165]
    s_waitcnt lgkmcnt(3)
    v_mfma_f32_16x16x32_bf16 v[158:161], v[82:85], v[114:117], v[158:161]
    v_mfma_f32_16x16x32_bf16 v[162:165], v[86:89], v[114:117], v[162:165]
    v_mfma_f32_16x16x32_bf16 v[158:161], v[86:89], v[110:113], v[158:161]
    v_mfma_f32_16x16x32_bf16 v[162:165], v[90:93], v[110:113], v[162:165]
    v_mfma_f32_16x16x32_bf16 v[158:161], v[90:93], v[106:109], v[158:161]
    v_mfma_f32_16x16x32_bf16 v[162:165], v[94:97], v[106:109], v[162:165]
    s_waitcnt lgkmcnt(0)
    v_mfma_f32_16x16x32_bf16 v[158:161], v[94:97], v[102:105], v[158:161]
    v_mfma_f32_16x16x32_bf16 v[162:165], v[98:101], v[102:105], v[162:165]
    s_nop 6
    v_cvt_pk_bf16_f32 v158, v158, v159
    v_cvt_pk_bf16_f32 v159, v160, v161
    v_cvt_pk_bf16_f32 v160, v162, v163
    v_cvt_pk_bf16_f32 v161, v164, v165
    s_nop 0
    v_permlane16_swap_b32 v158, v160
    v_permlane16_swap_b32 v159, v161
    ds_write_b128 v4, v[158:161] offset:3072
    s_waitcnt lgkmcnt(0)
    s_barrier
    ds_read_b128 v[6:9], v0 offset:0
    v_mov_b32 v21, s62
    s_waitcnt lgkmcnt(0)
    v_mov_b32 v20, v9
    v_mov_b32 v9, s62
    buffer_store_dwordx4 v[6:9], v1, s[48:51], s92 offen sc1
    buffer_store_dwordx2 v[20:21], v5, s[48:51], s93 offen sc1
    s_branch L_fin
L_r2:
    s_cmp_lg_u32 s64, 2
    s_cbranch_scc1 L_r3
    s_mov_b32 s52, s20
    s_mov_b32 s53, s21
    s_mov_b32 s54, 1966080
    s_mov_b32 s55, 0x20000
    s_mov_b32 s56, s22
    s_mov_b32 s57, s23
    s_mov_b32 s58, 1966080
    s_mov_b32 s59, 0x20000
    v_lshrrev_b32 v6, 2, v1
    v_mul_u32_u24 v7, 3072, v6
    v_and_b32 v8, 3, v1
    v_lshl_add_u32 v7, v8, 4, v7
    s_lshl_b32 s91, s63, 6
    s_mul_i32 s92, s61, 491520
    s_add_u32 s91, s91, s92
    v_bfe_u32 v4, v1, 5, 1
    v_lshlrev_b32 v4, 1, v4
    v_xor_b32 v4, v4, v8
    v_lshlrev_b32 v4, 4, v4
    v_lshl_add_u32 v4, v6, 6, v4
    s_mul_i32 s84, s61, 20480
    s_add_u32 s84, s84, 1280
    v_add_u32 v2, s84, v4
    v_lshrrev_b32 v6, 4, v1
    v_bfe_u32 v4, v1, 2, 2
    v_lshl_add_u32 v4, v6, 3, v4
    v_lshlrev_b32 v4, 6, v4
    v_lshl_add_u32 v4, v8, 3, v4
    v_and_b32 v6, 1, v6
    v_lshl_add_u32 v4, v6, 5, v4
    v_add_u32 v4, s84, v4
    v_xor_b32 v3, 32, v4
    s_barrier
    s_barrier
    buffer_load_dwordx4 v[64:67], v7, s[52:55], s91 offen
    buffer_load_dwordx4 v[104:107], v7, s[56:59], s91 offen
    s_add_u32 s91, s91, 49152
    buffer_load_dwordx4 v[68:71], v7, s[52:55], s91 offen
    buffer_load_dwordx4 v[108:111], v7, s[56:59], s91 offen
    s_add_u32 s91, s91, 49152
    buffer_load_dwordx4 v[72:75], v7, s[52:55], s91 offen
    buffer_load_dwordx4 v[112:115], v7, s[56:59], s91 offen
    s_add_u32 s91, s91, 49152
    buffer_load_dwordx4 v[76:79], v7, s[52:55], s91 offen
    buffer_load_dwordx4 v[116:119], v7, s[56:59], s91 offen
    s_add_u32 s91, s91, 49152
    buffer_load_dwordx4 v[80:83], v7, s[52:55], s91 offen
    buffer_load_dwordx4 v[120:123], v7, s[56:59], s91 offen
    s_add_u32 s91, s91, 49152
    buffer_load_dwordx4 v[84:87], v7, s[52:55], s91 offen
    buffer_load_dwordx4 v[124:127], v7, s[56:59], s91 offen
    s_add_u32 s91, s91, 49152
    buffer_load_dwordx4 v[88:91], v7, s[52:55], s91 offen
    buffer_load_dwordx4 v[128:131], v7, s[56:59], s91 offen
    s_add_u32 s91, s91, 49152
    buffer_load_dwordx4 v[92:95], v7, s[52:55], s91 offen
    buffer_load_dwordx4 v[132:135], v7, s[56:59], s91 offen
    s_add_u32 s91, s91, 49152
    buffer_load_dwordx4 v[96:99], v7, s[52:55], s91 offen
    buffer_load_dwordx4 v[136:139], v7, s[56:59], s91 offen
    s_add_u32 s91, s91, 49152
    buffer_load_dwordx4 v[100:103], v7, s[52:55], s91 offen
    buffer_load_dwordx4 v[140:143], v7, s[56:59], s91 offen
    s_waitcnt vmcnt(18)
    ds_write_b128 v2, v[64:67] offset:0
    ds_write_b128 v2, v[104:107] offset:10240
    s_waitcnt vmcnt(16)
    ds_write_b128 v2, v[68:71] offset:1024
    ds_write_b128 v2, v[108:111] offset:11264
    s_waitcnt vmcnt(14)
    ds_write_b128 v2, v[72:75] offset:2048
    ds_write_b128 v2, v[112:115] offset:12288
    s_waitcnt vmcnt(12)
    ds_write_b128 v2, v[76:79] offset:3072
    ds_write_b128 v2, v[116:119] offset:13312
    s_waitcnt vmcnt(10)
    ds_write_b128 v2, v[80:83] offset:4096
    ds_write_b128 v2, v[120:123] offset:14336
    s_waitcnt vmcnt(8)
    ds_write_b128 v2, v[84:87] offset:5120
    ds_write_b128 v2, v[124:127] offset:15360
    s_waitcnt vmcnt(6)
    ds_write_b128 v2, v[88:91] offset:6144
    ds_write_b128 v2, v[128:131] offset:16384
    s_waitcnt vmcnt(4)
    ds_write_b128 v2, v[92:95] offset:7168
    ds_write_b128 v2, v[132:135] offset:17408
    s_waitcnt vmcnt(2)
    ds_write_b128 v2, v[96:99] offset:8192
    ds_write_b128 v2, v[136:139] offset:18432
    s_waitcnt vmcnt(0)
    ds_write_b128 v2, v[100:103] offset:9216
    ds_write_b128 v2, v[140:143] offset:19456
    s_waitcnt lgkmcnt(0)
    ds_read_b64_tr_b16 v[64:65], v4 offset:0
    ds_read_b64_tr_b16 v[66:67], v4 offset:256
    ds_read_b64_tr_b16 v[68:69], v3 offset:0
    ds_read_b64_tr_b16 v[70:71], v3 offset:256
    ds_read_b64_tr_b16 v[72:73], v4 offset:10240
    ds_read_b64_tr_b16 v[74:75], v4 offset:10496
    ds_read_b64_tr_b16 v[76:77], v3 offset:10240
    ds_read_b64_tr_b16 v[78:79], v3 offset:10496
    s_waitcnt lgkmcnt(7)
    ds_read_b64_tr_b16 v[80:81], v4 offset:2048
    ds_read_b64_tr_b16 v[82:83], v4 offset:2304
    ds_read_b64_tr_b16 v[84:85], v3 offset:2048
    ds_read_b64_tr_b16 v[86:87], v3 offset:2304
    ds_read_b64_tr_b16 v[88:89], v4 offset:12288
    ds_read_b64_tr_b16 v[90:91], v4 offset:12544
    ds_read_b64_tr_b16 v[92:93], v3 offset:12288
    ds_read_b64_tr_b16 v[94:95], v3 offset:12544
    s_waitcnt lgkmcnt(7)
    ds_read_b64_tr_b16 v[96:97], v4 offset:4096
    ds_read_b64_tr_b16 v[98:99], v4 offset:4352
    ds_read_b64_tr_b16 v[100:101], v3 offset:4096
    ds_read_b64_tr_b16 v[102:103], v3 offset:4352
    ds_read_b64_tr_b16 v[104:105], v4 offset:14336
    ds_read_b64_tr_b16 v[106:107], v4 offset:14592
    ds_read_b64_tr_b16 v[108:109], v3 offset:14336
    ds_read_b64_tr_b16 v[110:111], v3 offset:14592
    s_waitcnt lgkmcnt(7)
    ds_read_b64_tr_b16 v[112:113], v4 offset:6144
    ds_read_b64_tr_b16 v[114:115], v4 offset:6400
    ds_read_b64_tr_b16 v[116:117], v3 offset:6144
    ds_read_b64_tr_b16 v[118:119], v3 offset:6400
    ds_read_b64_tr_b16 v[120:121], v4 offset:16384
    ds_read_b64_tr_b16 v[122:123], v4 offset:16640
    ds_read_b64_tr_b16 v[124:125], v3 offset:16384
    ds_read_b64_tr_b16 v[126:127], v3 offset:16640
    s_waitcnt lgkmcnt(7)
    ds_read_b64_tr_b16 v[128:129], v4 offset:8192
    ds_read_b64_tr_b16 v[130:131], v4 offset:8448
    ds_read_b64_tr_b16 v[132:133], v3 offset:8192
    ds_read_b64_tr_b16 v[134:135], v3 offset:8448
    ds_read_b64_tr_b16 v[136:137], v4 offset:18432
    ds_read_b64_tr_b16 v[138:139], v4 offset:18688
    ds_read_b64_tr_b16 v[140:141], v3 offset:18432
    ds_read_b64_tr_b16 v[142:143], v3 offset:18688
    s_waitcnt lgkmcnt(7)
    v_and_b32 v7, 15, v1
    v_lshrrev_b32 v6, 4, v1
    v_mul_u32_u24 v4, 1312, v7
    s_mul_i32 s85, s61, 320
    v_add_u32 v4, s85, v4
    v_min_u32 v4, 10496, v4
    v_lshl_add_u32 v4, v6, 4, v4
    v_add_u32 v4, 83200, v4
    v_lshlrev_b32 v2, 4, v1
    v_add_u32 v3, s84, v2
    s_lshl_b32 s84, s61, 10
    s_add_u32 s84, s84, 1280
    v_add_u32 v2, s84, v2
    v_lshlrev_b32 v5, 4, v7
    v_lshl_add_u32 v5, v6, 7, v5
    v_and_b32 v7, 7, v7
    v_lshlrev_b32 v7, 3, v7
    s_lshl_b32 s85, s63, 1
    s_add_u32 s85, s85, s61
    s_lshl_b32 s85, s85, 9
    s_add_u32 s85, s85, 9043968
    s_mov_b32 s84, 0xbfb8aa3b
    v_mov_b32 v46, s62
    v_mov_b32 v47, s62
    s_waitcnt lgkmcnt(0)
    s_barrier
    ds_read_b128 v[24:27], v4 offset:0
    ds_read_b128 v[28:31], v4 offset:64
    ds_read_b128 v[32:35], v4 offset:128
    ds_read_b128 v[36:39], v4 offset:192
    ds_read_b128 v[40:43], v4 offset:256
    ds_read_b64 v[48:49], v7 offset:272
    s_waitcnt lgkmcnt(5)
    v_mfma_f32_16x16x32_bf16 v[8:11], v[64:67], v[24:27], 0
    v_mfma_f32_16x16x32_bf16 v[12:15], v[68:71], v[24:27], 0
    v_mfma_f32_16x16x32_bf16 v[16:19], v[72:75], v[24:27], 0
    v_mfma_f32_16x16x32_bf16 v[20:23], v[76:79], v[24:27], 0
    s_waitcnt lgkmcnt(4)
    v_mfma_f32_16x16x32_bf16 v[8:11], v[80:83], v[28:31], v[8:11]
    v_mfma_f32_16x16x32_bf16 v[12:15], v[84:87], v[28:31], v[12:15]
    v_mfma_f32_16x16x32_bf16 v[16:19], v[88:91], v[28:31], v[16:19]
    v_mfma_f32_16x16x32_bf16 v[20:23], v[92:95], v[28:31], v[20:23]
    s_waitcnt lgkmcnt(3)
    v_mfma_f32_16x16x32_bf16 v[8:11], v[96:99], v[32:35], v[8:11]
    v_mfma_f32_16x16x32_bf16 v[12:15], v[100:103], v[32:35], v[12:15]
    v_mfma_f32_16x16x32_bf16 v[16:19], v[104:107], v[32:35], v[16:19]
    v_mfma_f32_16x16x32_bf16 v[20:23], v[108:111], v[32:35], v[20:23]
    s_waitcnt lgkmcnt(2)
    v_mfma_f32_16x16x32_bf16 v[8:11], v[112:115], v[36:39], v[8:11]
    v_mfma_f32_16x16x32_bf16 v[12:15], v[116:119], v[36:39], v[12:15]
    v_mfma_f32_16x16x32_bf16 v[16:19], v[120:123], v[36:39], v[16:19]
    v_mfma_f32_16x16x32_bf16 v[20:23], v[124:127], v[36:39], v[20:23]
    s_waitcnt lgkmcnt(1)
    v_mfma_f32_16x16x32_bf16 v[8:11], v[128:131], v[40:43], v[8:11]
    v_mfma_f32_16x16x32_bf16 v[12:15], v[132:135], v[40:43], v[12:15]
    v_mfma_f32_16x16x32_bf16 v[16:19], v[136:139], v[40:43], v[16:19]
    v_mfma_f32_16x16x32_bf16 v[20:23], v[140:143], v[40:43], v[20:23]
    s_nop 4
    ds_write_b128 v3, v[8:11] offset:0
    ds_write_b128 v3, v[12:15] offset:1024
    ds_write_b128 v3, v[16:19] offset:2048
    ds_write_b128 v3, v[20:23] offset:3072
    s_waitcnt lgkmcnt(0)
    s_barrier
    s_cmp_ge_u32 s61, 2
    s_cbranch_scc1 L_ffn1_done_48
    ds_read_b128 v[128:131], v2 offset:0
    ds_read_b128 v[132:135], v2 offset:2048
    ds_read_b128 v[136:139], v2 offset:20480
    ds_read_b128 v[140:143], v2 offset:22528
    ds_read_b128 v[144:147], v2 offset:40960
    ds_read_b128 v[148:151], v2 offset:43008
    ds_read_b128 v[152:155], v2 offset:61440
    ds_read_b128 v[156:159], v2 offset:63488
    v_sub_f32 v84, 0, v48
    v_mov_b32 v85, v49
    v_mov_b32 v4, v5
    s_waitcnt lgkmcnt(4)
    v_pk_add_f32 v[128:129], v[128:129], v[136:137]
    v_pk_add_f32 v[130:131], v[130:131], v[138:139]
    v_pk_add_f32 v[132:133], v[132:133], v[140:141]
    v_pk_add_f32 v[134:135], v[134:135], v[142:143]
    s_waitcnt lgkmcnt(0)
    v_pk_add_f32 v[144:145], v[144:145], v[152:153]
    v_pk_add_f32 v[146:147], v[146:147], v[154:155]
    v_pk_add_f32 v[148:149], v[148:149], v[156:157]
    v_pk_add_f32 v[150:151], v[150:151], v[158:159]
    v_pk_add_f32 v[128:129], v[128:129], v[144:145]
    v_pk_add_f32 v[130:131], v[130:131], v[146:147]
    v_pk_add_f32 v[132:133], v[132:133], v[148:149]
    v_pk_add_f32 v[134:135], v[134:135], v[150:151]
    v_fmac_f32_dpp v128, v128, v84 row_ror:8 row_mask:0xf bank_mask:0xf
    v_fmac_f32_dpp v129, v129, v84 row_ror:8 row_mask:0xf bank_mask:0xf
    v_fmac_f32_dpp v130, v130, v84 row_ror:8 row_mask:0xf bank_mask:0xf
    v_fmac_f32_dpp v131, v131, v84 row_ror:8 row_mask:0xf bank_mask:0xf
    v_fmac_f32_dpp v132, v132, v84 row_ror:8 row_mask:0xf bank_mask:0xf
    v_fmac_f32_dpp v133, v133, v84 row_ror:8 row_mask:0xf bank_mask:0xf
    v_fmac_f32_dpp v134, v134, v84 row_ror:8 row_mask:0xf bank_mask:0xf
    v_fmac_f32_dpp v135, v135, v84 row_ror:8 row_mask:0xf bank_mask:0xf
    v_pk_mul_f32 v[128:129], v[128:129], v[84:85] op_sel:[0,1] op_sel_hi:[1,1]
    v_pk_mul_f32 v[130:131], v[130:131], v[84:85] op_sel:[0,1] op_sel_hi:[1,1]
    v_pk_mul_f32 v[132:133], v[132:133], v[84:85] op_sel:[0,1] op_sel_hi:[1,1]
    v_pk_mul_f32 v[134:135], v[134:135], v[84:85] op_sel:[0,1] op_sel_hi:[1,1]
    v_cvt_pk_bf16_f32 v140, v128, v129
    v_cvt_pk_bf16_f32 v141, v130, v131
    v_cvt_pk_bf16_f32 v142, v132, v133
    v_cvt_pk_bf16_f32 v143, v134, v135
    v_lshlrev_b32 v128, 16, v140
    v_and_b32 v129, s86, v140
    v_lshlrev_b32 v130, 16, v141
    v_and_b32 v131, s86, v141
    v_lshlrev_b32 v132, 16, v142
    v_and_b32 v133, s86, v142
    v_lshlrev_b32 v134, 16, v143
    v_and_b32 v135, s86, v143
    v_mul_f32 v136, s84, v128
    v_mul_f32 v137, s84, v129
    v_mul_f32 v138, s84, v130
    v_mul_f32 v139, s84, v131
    v_exp_f32 v136, v136
    v_exp_f32 v137, v137
    v_exp_f32 v138, v138
    v_exp_f32 v139, v139
    v_add_f32 v136, 1.0, v136
    v_add_f32 v137, 1.0, v137
    v_add_f32 v138, 1.0, v138
    v_add_f32 v139, 1.0, v139
    v_rcp_f32 v136, v136
    v_rcp_f32 v137, v137
    v_rcp_f32 v138, v138
    v_rcp_f32 v139, v139
    v_mul_f32 v128, v128, v136
    v_mul_f32 v129, v129, v137
    v_mul_f32 v130, v130, v138
    v_mul_f32 v131, v131, v139
    v_cvt_pk_bf16_f32 v140, v128, v129
    v_cvt_pk_bf16_f32 v141, v130, v131
    v_lshlrev_b32 v128, 16, v140
    v_and_b32 v129, s86, v140
    v_lshlrev_b32 v130, 16, v141
    v_and_b32 v131, s86, v141
    v_pk_mul_f32 v[128:129], v[128:129], v[132:133]
    v_pk_mul_f32 v[130:131], v[130:131], v[134:135]
    s_mov_b32 s82, 0x00ff00ff
    v_cvt_pk_bf16_f32 v44, v128, v129
    v_cvt_pk_bf16_f32 v45, v130, v131
    s_mov_b32 exec_lo, s82
    s_mov_b32 exec_hi, s82
    buffer_store_dwordx4 v[44:47], v4, s[48:51], s85 offen sc1
    s_mov_b64 exec, -1
L_ffn1_done_48:
    s_branch L_fin
L_r3:
    s_cmp_lg_u32 s64, 3
    s_cbranch_scc1 L_r0
    s_mov_b32 s52, s24
    s_mov_b32 s53, s25
    s_mov_b32 s54, 1966080
    s_mov_b32 s55, 0x20000
    s_barrier
    s_barrier
    v_lshrrev_b32 v6, 1, v1
    v_mul_u32_u24 v6, 1280, v6
    v_and_b32 v7, 1, v1
    v_lshl_add_u32 v6, v7, 4, v6
    s_lshl_b32 s91, s63, 5
    s_mul_i32 s92, s61, 491520
    s_add_u32 s91, s91, s92
    buffer_load_dwordx4 v[64:67], v6, s[52:55], s91 offen
    s_add_u32 s91, s91, 40960
    buffer_load_dwordx4 v[68:71], v6, s[52:55], s91 offen
    s_add_u32 s91, s91, 40960
    buffer_load_dwordx4 v[72:75], v6, s[52:55], s91 offen
    s_add_u32 s91, s91, 40960
    buffer_load_dwordx4 v[76:79], v6, s[52:55], s91 offen
    s_add_u32 s91, s91, 40960
    buffer_load_dwordx4 v[80:83], v6, s[52:55], s91 offen
    s_add_u32 s91, s91, 40960
    buffer_load_dwordx4 v[84:87], v6, s[52:55], s91 offen
    s_add_u32 s91, s91, 40960
    buffer_load_dwordx4 v[88:91], v6, s[52:55], s91 offen
    s_add_u32 s91, s91, 40960
    buffer_load_dwordx4 v[92:95], v6, s[52:55], s91 offen
    s_add_u32 s91, s91, 40960
    buffer_load_dwordx4 v[96:99], v6, s[52:55], s91 offen
    s_add_u32 s91, s91, 40960
    buffer_load_dwordx4 v[100:103], v6, s[52:55], s91 offen
    s_add_u32 s91, s91, 40960
    buffer_load_dwordx4 v[104:107], v6, s[52:55], s91 offen
    s_add_u32 s91, s91, 40960
    buffer_load_dwordx4 v[108:111], v6, s[52:55], s91 offen
    s_mul_i32 s91, s61, 12288
    s_add_u32 s85, s91, 1280
    v_lshlrev_b32 v4, 4, v1
    v_add_u32 v3, s85, v4
    v_lshlrev_b32 v2, 3, v1
    v_add_u32 v2, s85, v2
    s_lshl_b32 s84, s61, 10
    v_add_u32 v5, s84, v4
    v_and_b32 v4, 7, v1
    v_lshlrev_b32 v4, 4, v4
    v_lshrrev_b32 v6, 4, v1
    v_lshl_add_u32 v4, v6, 7, v4
    v_bfe_u32 v6, v1, 3, 1
    v_lshl_add_u32 v4, v6, 9, v4
    s_add_u32 s91, s91, 9043968
    s_add_u32 s92, s91, 4096
    s_add_u32 s93, s91, 8192
    s_waitcnt vmcnt(11)
    ds_write_b128 v3, v[64:67] offset:0
    s_waitcnt vmcnt(10)
    ds_write_b128 v3, v[68:71] offset:1024
    s_waitcnt vmcnt(9)
    ds_write_b128 v3, v[72:75] offset:2048
    s_waitcnt vmcnt(8)
    ds_write_b128 v3, v[76:79] offset:3072
    s_waitcnt vmcnt(7)
    ds_write_b128 v3, v[80:83] offset:4096
    s_waitcnt vmcnt(6)
    ds_write_b128 v3, v[84:87] offset:5120
    s_waitcnt vmcnt(5)
    ds_write_b128 v3, v[88:91] offset:6144
    s_waitcnt vmcnt(4)
    ds_write_b128 v3, v[92:95] offset:7168
    s_waitcnt vmcnt(3)
    ds_write_b128 v3, v[96:99] offset:8192
    s_waitcnt vmcnt(2)
    ds_write_b128 v3, v[100:103] offset:9216
    s_waitcnt vmcnt(1)
    ds_write_b128 v3, v[104:107] offset:10240
    s_waitcnt vmcnt(0)
    ds_write_b128 v3, v[108:111] offset:11264
    s_waitcnt lgkmcnt(0)
    ds_read_b64_tr_b16 v[112:113], v2 offset:0
    ds_read_b64_tr_b16 v[114:115], v2 offset:512
    ds_read_b64_tr_b16 v[116:117], v2 offset:1024
    ds_read_b64_tr_b16 v[118:119], v2 offset:1536
    ds_read_b64_tr_b16 v[120:121], v2 offset:2048
    ds_read_b64_tr_b16 v[122:123], v2 offset:2560
    ds_read_b64_tr_b16 v[124:125], v2 offset:3072
    ds_read_b64_tr_b16 v[126:127], v2 offset:3584
    ds_read_b64_tr_b16 v[128:129], v2 offset:4096
    ds_read_b64_tr_b16 v[130:131], v2 offset:4608
    ds_read_b64_tr_b16 v[132:133], v2 offset:5120
    ds_read_b64_tr_b16 v[134:135], v2 offset:5632
    s_waitcnt lgkmcnt(0)
    ds_read_b64_tr_b16 v[136:137], v2 offset:6144
    ds_read_b64_tr_b16 v[138:139], v2 offset:6656
    ds_read_b64_tr_b16 v[140:141], v2 offset:7168
    ds_read_b64_tr_b16 v[142:143], v2 offset:7680
    ds_read_b64_tr_b16 v[144:145], v2 offset:8192
    ds_read_b64_tr_b16 v[146:147], v2 offset:8704
    ds_read_b64_tr_b16 v[148:149], v2 offset:9216
    ds_read_b64_tr_b16 v[150:151], v2 offset:9728
    ds_read_b64_tr_b16 v[152:153], v2 offset:10240
    ds_read_b64_tr_b16 v[154:155], v2 offset:10752
    ds_read_b64_tr_b16 v[156:157], v2 offset:11264
    ds_read_b64_tr_b16 v[158:159], v2 offset:11776
    s_waitcnt lgkmcnt(0)
    s_mov_b32 s95, 0
    s_mul_i32 s83, s62, 1
    s_mov_b64 s[4:5], -1
    s_mov_b64 s[6:7], -1
    s_mov_b64 s[8:9], -1
    s_mov_b64 s[10:11], -1
    s_mov_b64 s[12:13], -1
    s_mov_b64 s[14:15], -1
    s_mov_b64 s[16:17], -1
    s_mov_b64 s[18:19], -1
    s_mov_b64 s[20:21], -1
    s_mov_b64 s[22:23], -1
    s_mov_b64 s[24:25], -1
    s_mov_b64 s[26:27], -1
L_poll_49:
    s_mov_b64 exec, s[4:5]
    buffer_load_dwordx3 v[64:66], v4, s[48:51], s91 offen offset:0 sc1
    s_mov_b64 exec, s[6:7]
    buffer_load_dwordx3 v[68:70], v4, s[48:51], s91 offen offset:1024 sc1
    s_mov_b64 exec, s[8:9]
    buffer_load_dwordx3 v[72:74], v4, s[48:51], s91 offen offset:2048 sc1
    s_mov_b64 exec, s[10:11]
    buffer_load_dwordx3 v[76:78], v4, s[48:51], s91 offen offset:3072 sc1
    s_mov_b64 exec, s[12:13]
    buffer_load_dwordx3 v[80:82], v4, s[48:51], s92 offen offset:0 sc1
    s_mov_b64 exec, s[14:15]
    buffer_load_dwordx3 v[84:86], v4, s[48:51], s92 offen offset:1024 sc1
    s_mov_b64 exec, s[16:17]
    buffer_load_dwordx3 v[88:90], v4, s[48:51], s92 offen offset:2048 sc1
    s_mov_b64 exec, s[18:19]
    buffer_load_dwordx3 v[92:94], v4, s[48:51], s92 offen offset:3072 sc1
    s_mov_b64 exec, s[20:21]
    buffer_load_dwordx3 v[96:98], v4, s[48:51], s93 offen offset:0 sc1
    s_mov_b64 exec, s[22:23]
    buffer_load_dwordx3 v[100:102], v4, s[48:51], s93 offen offset:1024 sc1
    s_mov_b64 exec, s[24:25]
    buffer_load_dwordx3 v[104:106], v4, s[48:51], s93 offen offset:2048 sc1
    s_mov_b64 exec, s[26:27]
    buffer_load_dwordx3 v[108:110], v4, s[48:51], s93 offen offset:3072 sc1
    s_mov_b64 exec, -1
L_chk_51:
    s_waitcnt vmcnt(0)
    v_cmp_ne_u32 s[4:5], s83, v66
    v_cmp_ne_u32 s[6:7], s83, v70
    v_cmp_ne_u32 s[8:9], s83, v74
    v_cmp_ne_u32 s[10:11], s83, v78
    v_cmp_ne_u32 s[12:13], s83, v82
    v_cmp_ne_u32 s[14:15], s83, v86
    v_cmp_ne_u32 s[16:17], s83, v90
    v_cmp_ne_u32 s[18:19], s83, v94
    v_cmp_ne_u32 s[20:21], s83, v98
    v_cmp_ne_u32 s[22:23], s83, v102
    v_cmp_ne_u32 s[24:25], s83, v106
    v_cmp_ne_u32 s[26:27], s83, v110
    s_add_u32 s95, s95, 1
    s_or_b64 vcc, s[4:5], s[6:7]
    s_or_b64 vcc, vcc, s[8:9]
    s_or_b64 vcc, vcc, s[10:11]
    s_or_b64 vcc, vcc, s[12:13]
    s_or_b64 vcc, vcc, s[14:15]
    s_or_b64 vcc, vcc, s[16:17]
    s_or_b64 vcc, vcc, s[18:19]
    s_or_b64 vcc, vcc, s[20:21]
    s_or_b64 vcc, vcc, s[22:23]
    s_or_b64 vcc, vcc, s[24:25]
    s_or_b64 vcc, vcc, s[26:27]
    s_cbranch_scc0 L_polled_50
    s_sleep 1
    s_cmp_lt_u32 s95, 400000
    s_cbranch_scc1 L_poll_49
L_polled_50:
    v_mfma_f32_16x16x16_bf16 v[8:11], v[112:113], v[64:65], 0
    v_mfma_f32_16x16x16_bf16 v[12:15], v[114:115], v[64:65], 0
    v_mfma_f32_16x16x16_bf16 v[8:11], v[116:117], v[68:69], v[8:11]
    v_mfma_f32_16x16x16_bf16 v[12:15], v[118:119], v[68:69], v[12:15]
    v_mfma_f32_16x16x16_bf16 v[8:11], v[120:121], v[72:73], v[8:11]
    v_mfma_f32_16x16x16_bf16 v[12:15], v[122:123], v[72:73], v[12:15]
    v_mfma_f32_16x16x16_bf16 v[8:11], v[124:125], v[76:77], v[8:11]
    v_mfma_f32_16x16x16_bf16 v[12:15], v[126:127], v[76:77], v[12:15]
    v_mfma_f32_16x16x16_bf16 v[8:11], v[128:129], v[80:81], v[8:11]
    v_mfma_f32_16x16x16_bf16 v[12:15], v[130:131], v[80:81], v[12:15]
    v_mfma_f32_16x16x16_bf16 v[8:11], v[132:133], v[84:85], v[8:11]
    v_mfma_f32_16x16x16_bf16 v[12:15], v[134:135], v[84:85], v[12:15]
    v_mfma_f32_16x16x16_bf16 v[8:11], v[136:137], v[88:89], v[8:11]
    v_mfma_f32_16x16x16_bf16 v[12:15], v[138:139], v[88:89], v[12:15]
    v_mfma_f32_16x16x16_bf16 v[8:11], v[140:141], v[92:93], v[8:11]
    v_mfma_f32_16x16x16_bf16 v[12:15], v[142:143], v[92:93], v[12:15]
    v_mfma_f32_16x16x16_bf16 v[8:11], v[144:145], v[96:97], v[8:11]
    v_mfma_f32_16x16x16_bf16 v[12:15], v[146:147], v[96:97], v[12:15]
    v_mfma_f32_16x16x16_bf16 v[8:11], v[148:149], v[100:101], v[8:11]
    v_mfma_f32_16x16x16_bf16 v[12:15], v[150:151], v[100:101], v[12:15]
    v_mfma_f32_16x16x16_bf16 v[8:11], v[152:153], v[104:105], v[8:11]
    v_mfma_f32_16x16x16_bf16 v[12:15], v[154:155], v[104:105], v[12:15]
    v_mfma_f32_16x16x16_bf16 v[8:11], v[156:157], v[108:109], v[8:11]
    v_mfma_f32_16x16x16_bf16 v[12:15], v[158:159], v[108:109], v[12:15]
    s_nop 7
    v_add_f32_dpp v8, v12, v8 row_ror:8 row_mask:0xf bank_mask:0xf
    v_add_f32_dpp v9, v13, v9 row_ror:8 row_mask:0xf bank_mask:0xf
    v_add_f32_dpp v10, v14, v10 row_ror:8 row_mask:0xf bank_mask:0xf
    v_add_f32_dpp v11, v15, v11 row_ror:8 row_mask:0xf bank_mask:0xf
    ds_write_b128 v5, v[8:11] offset:50432
    s_waitcnt lgkmcnt(0)
    s_barrier
    s_branch L_fin
L_r0:
    s_setprio 2
    s_barrier
    v_lshlrev_b32 v4, 4, v0
    s_mov_b32 s84, 8912896
    s_mov_b32 s85, 8916992
    s_mov_b32 s90, 8921088
    s_mov_b32 s91, 8925184
    s_mov_b32 s95, 0
    s_mul_i32 s83, s62, 8
L_poll_59:
    buffer_load_dwordx4 v[44:47], v4, s[48:51], s84 offen sc1
    buffer_load_dwordx4 v[48:51], v4, s[48:51], s85 offen sc1
    buffer_load_dwordx4 v[52:55], v4, s[48:51], s90 offen sc1
    buffer_load_dwordx4 v[56:59], v4, s[48:51], s91 offen sc1
L_chk_61:
    s_waitcnt vmcnt(0)
    v_add_u32 v42, v45, v47
    v_add3_u32 v42, v42, v49, v51
    v_add3_u32 v42, v42, v53, v55
    v_add3_u32 v42, v42, v57, v59
    v_cmp_ne_u32 vcc, s83, v42
    s_add_u32 s95, s95, 1
    s_and_b64 exec, vcc, vcc
    s_cbranch_execz L_polled_60
    s_sleep 1
    s_cmp_lt_u32 s95, 400000
    s_cbranch_scc1 L_poll_59
L_polled_60:
    s_mov_b64 exec, -1
    v_max3_u32 v61, v44, v46, v48
    v_max3_u32 v62, v50, v52, v54
    v_max3_u32 v61, v61, v56, v58
    v_lshrrev_b32 v2, 4, v0
    v_max_u32 v61, v61, v62
    v_lshlrev_b32 v2, 2, v2
    s_nop 0
    v_max_u32_dpp v62, v61, v61 row_ror:8 row_mask:0xf bank_mask:0xf
    s_nop 1
    v_max_u32_dpp v62, v62, v62 row_ror:4 row_mask:0xf bank_mask:0xf
    s_nop 1
    v_max_u32_dpp v62, v62, v62 row_ror:2 row_mask:0xf bank_mask:0xf
    s_nop 1
    v_max_u32_dpp v62, v62, v62 row_ror:1 row_mask:0xf bank_mask:0xf
    s_mov_b32 s84, 0x00010001
    s_mov_b32 exec_lo, s84
    s_mov_b32 exec_hi, s84
    ds_write_b32 v2, v62 offset:576
    s_mov_b64 exec, -1
    v_and_b32 v8, 15, v1
    v_lshlrev_b32 v8, 2, v8
    s_waitcnt lgkmcnt(0)
    s_barrier
    ds_read_b32 v60, v8 offset:576
    v_mov_b32 v6, 208
    v_mov_b32 v43, 1
    s_waitcnt lgkmcnt(0)
L_sel_rank_55:
    v_mov_b32 v62, 0
    v_sub_co_u32_dpp v63, vcc, v60, v60 row_ror:1 row_mask:0xf bank_mask:0xf
    v_addc_co_u32 v62, vcc, 0, v62, vcc
    s_nop 0
    v_sub_co_u32_dpp v63, vcc, v60, v60 row_ror:2 row_mask:0xf bank_mask:0xf
    v_addc_co_u32 v62, vcc, 0, v62, vcc
    s_nop 0
    v_sub_co_u32_dpp v63, vcc, v60, v60 row_ror:3 row_mask:0xf bank_mask:0xf
    v_addc_co_u32 v62, vcc, 0, v62, vcc
    s_nop 0
    v_sub_co_u32_dpp v63, vcc, v60, v60 row_ror:4 row_mask:0xf bank_mask:0xf
    v_addc_co_u32 v62, vcc, 0, v62, vcc
    s_nop 0
    v_sub_co_u32_dpp v63, vcc, v60, v60 row_ror:5 row_mask:0xf bank_mask:0xf
    v_addc_co_u32 v62, vcc, 0, v62, vcc
    s_nop 0
    v_sub_co_u32_dpp v63, vcc, v60, v60 row_ror:6 row_mask:0xf bank_mask:0xf
    v_addc_co_u32 v62, vcc, 0, v62, vcc
    s_nop 0
    v_sub_co_u32_dpp v63, vcc, v60, v60 row_ror:7 row_mask:0xf bank_mask:0xf
    v_addc_co_u32 v62, vcc, 0, v62, vcc
    s_nop 0
    v_sub_co_u32_dpp v63, vcc, v60, v60 row_ror:8 row_mask:0xf bank_mask:0xf
    v_addc_co_u32 v62, vcc, 0, v62, vcc
    s_nop 0
    v_sub_co_u32_dpp v63, vcc, v60, v60 row_ror:9 row_mask:0xf bank_mask:0xf
    v_addc_co_u32 v62, vcc, 0, v62, vcc
    s_nop 0
    v_sub_co_u32_dpp v63, vcc, v60, v60 row_ror:10 row_mask:0xf bank_mask:0xf
    v_addc_co_u32 v62, vcc, 0, v62, vcc
    s_nop 0
    v_sub_co_u32_dpp v63, vcc, v60, v60 row_ror:11 row_mask:0xf bank_mask:0xf
    v_addc_co_u32 v62, vcc, 0, v62, vcc
    s_nop 0
    v_sub_co_u32_dpp v63, vcc, v60, v60 row_ror:12 row_mask:0xf bank_mask:0xf
    v_addc_co_u32 v62, vcc, 0, v62, vcc
    s_nop 0
    v_sub_co_u32_dpp v63, vcc, v60, v60 row_ror:13 row_mask:0xf bank_mask:0xf
    v_addc_co_u32 v62, vcc, 0, v62, vcc
    s_nop 0
    v_sub_co_u32_dpp v63, vcc, v60, v60 row_ror:14 row_mask:0xf bank_mask:0xf
    v_addc_co_u32 v62, vcc, 0, v62, vcc
    s_nop 0
    v_sub_co_u32_dpp v63, vcc, v60, v60 row_ror:15 row_mask:0xf bank_mask:0xf
    v_addc_co_u32 v62, vcc, 0, v62, vcc
    v_cmp_eq_u32 vcc, 8, v62
    v_mov_b32 v63, v61
    s_ff1_i32_b64 s84, vcc
    v_readlane_b32 s85, v60, s84
L_sel_more_56:
    s_nop 1
    v_cmp_le_u32 vcc, s85, v63
    s_nop 0
    s_and_b64 exec, vcc, vcc
    s_cbranch_execz L_sel_nomore_57
    ds_add_rtn_u32 v62, v6, v43
    v_cmp_lt_u32 s[66:67], v44, v63
    v_cmp_lt_u32 s[68:69], v46, v63
    v_cmp_lt_u32 s[70:71], v48, v63
    v_cmp_lt_u32 s[72:73], v50, v63
    v_cmp_lt_u32 s[74:75], v52, v63
    v_cmp_lt_u32 s[76:77], v54, v63
    v_cmp_lt_u32 s[78:79], v56, v63
    v_cmp_lt_u32 s[80:81], v58, v63
    v_cndmask_b32 v45, 0, v44, s[66:67]
    v_cndmask_b32 v47, 0, v46, s[68:69]
    v_cndmask_b32 v49, 0, v48, s[70:71]
    v_cndmask_b32 v51, 0, v50, s[72:73]
    v_cndmask_b32 v53, 0, v52, s[74:75]
    v_cndmask_b32 v55, 0, v54, s[76:77]
    v_cndmask_b32 v57, 0, v56, s[78:79]
    v_cndmask_b32 v59, 0, v58, s[80:81]
    s_waitcnt lgkmcnt(0)
    v_min_u32 v62, 16, v62
    v_lshlrev_b32 v62, 2, v62
    ds_write_b32 v62, v63 offset:128
    v_max3_u32 v63, v45, v47, v49
    v_max3_u32 v62, v51, v53, v55
    v_max3_u32 v63, v63, v57, v59
    v_max_u32 v63, v63, v62
    s_branch L_sel_more_56
L_sel_nomore_57:
    s_mov_b64 exec, -1
    s_waitcnt lgkmcnt(0)
    s_barrier
    ds_read_b32 v62, v6
    ds_read_b32 v60, v8 offset:128
    s_waitcnt lgkmcnt(0)
    v_readfirstlane_b32 s84, v62
    s_nop 0
    s_cmp_le_u32 s84, 16
    s_cbranch_scc1 L_sel_done_58
    s_barrier
    v_lshlrev_b32 v4, 2, v1
    v_min_u32 v4, 80, v4
    v_mov_b32 v6, 0
    ds_write_b32 v4, v6 offset:128
    v_mov_b32 v6, 208
    s_waitcnt lgkmcnt(0)
    s_barrier
    s_branch L_sel_rank_55
L_sel_done_58:
    s_cmp_lg_u32 s61, 0
    s_cbranch_scc1 L_noidx_52
    v_mov_b32 v62, 0
    v_sub_co_u32_dpp v63, vcc, v60, v60 row_ror:1 row_mask:0xf bank_mask:0xf
    v_addc_co_u32 v62, vcc, 0, v62, vcc
    s_nop 0
    v_sub_co_u32_dpp v63, vcc, v60, v60 row_ror:2 row_mask:0xf bank_mask:0xf
    v_addc_co_u32 v62, vcc, 0, v62, vcc
    s_nop 0
    v_sub_co_u32_dpp v63, vcc, v60, v60 row_ror:3 row_mask:0xf bank_mask:0xf
    v_addc_co_u32 v62, vcc, 0, v62, vcc
    s_nop 0
    v_sub_co_u32_dpp v63, vcc, v60, v60 row_ror:4 row_mask:0xf bank_mask:0xf
    v_addc_co_u32 v62, vcc, 0, v62, vcc
    s_nop 0
    v_sub_co_u32_dpp v63, vcc, v60, v60 row_ror:5 row_mask:0xf bank_mask:0xf
    v_addc_co_u32 v62, vcc, 0, v62, vcc
    s_nop 0
    v_sub_co_u32_dpp v63, vcc, v60, v60 row_ror:6 row_mask:0xf bank_mask:0xf
    v_addc_co_u32 v62, vcc, 0, v62, vcc
    s_nop 0
    v_sub_co_u32_dpp v63, vcc, v60, v60 row_ror:7 row_mask:0xf bank_mask:0xf
    v_addc_co_u32 v62, vcc, 0, v62, vcc
    s_nop 0
    v_sub_co_u32_dpp v63, vcc, v60, v60 row_ror:8 row_mask:0xf bank_mask:0xf
    v_addc_co_u32 v62, vcc, 0, v62, vcc
    s_nop 0
    v_sub_co_u32_dpp v63, vcc, v60, v60 row_ror:9 row_mask:0xf bank_mask:0xf
    v_addc_co_u32 v62, vcc, 0, v62, vcc
    s_nop 0
    v_sub_co_u32_dpp v63, vcc, v60, v60 row_ror:10 row_mask:0xf bank_mask:0xf
    v_addc_co_u32 v62, vcc, 0, v62, vcc
    s_nop 0
    v_sub_co_u32_dpp v63, vcc, v60, v60 row_ror:11 row_mask:0xf bank_mask:0xf
    v_addc_co_u32 v62, vcc, 0, v62, vcc
    s_nop 0
    v_sub_co_u32_dpp v63, vcc, v60, v60 row_ror:12 row_mask:0xf bank_mask:0xf
    v_addc_co_u32 v62, vcc, 0, v62, vcc
    s_nop 0
    v_sub_co_u32_dpp v63, vcc, v60, v60 row_ror:13 row_mask:0xf bank_mask:0xf
    v_addc_co_u32 v62, vcc, 0, v62, vcc
    s_nop 0
    v_sub_co_u32_dpp v63, vcc, v60, v60 row_ror:14 row_mask:0xf bank_mask:0xf
    v_addc_co_u32 v62, vcc, 0, v62, vcc
    s_nop 0
    v_sub_co_u32_dpp v63, vcc, v60, v60 row_ror:15 row_mask:0xf bank_mask:0xf
    v_addc_co_u32 v62, vcc, 0, v62, vcc
    v_and_b32 v4, 2047, v60
    v_sub_u32 v44, 2047, v4
    v_mov_b32 v45, s62
    v_sub_u32 v62, 15, v62
    v_lshlrev_b32 v43, 3, v62
    v_cmp_gt_u32 vcc, 8, v62
    s_and_b32 s84, s2, 7
    s_lshl_b32 s85, s84, 7
    s_add_u32 s85, s85, 9109504
    s_and_b64 exec, vcc, 0xffff
    buffer_store_dwordx2 v[44:45], v43, s[48:51], s85 offen sc1
    s_cmp_lg_u32 s84, 0
    s_cbranch_scc1 L_noidx_52
    s_mov_b64 exec, 1
    v_mov_b32 v43, 9113600
    buffer_store_dword v45, v43, s[48:51], 0 offen sc1
L_noidx_52:
    s_mov_b64 exec, -1
L_fin:
L_end:
    s_endpgm
L_code_end:

.section .rodata,"a"
.p2align 6
.amdhsa_kernel recurrent_scan__ssm_conv_h3__moe_arch_mod__prompt_kernel
  .amdhsa_next_free_vgpr 168
  .amdhsa_next_free_sgpr 102
  .amdhsa_accum_offset 168
  .amdhsa_group_segment_fixed_size 0
  .amdhsa_kernarg_size 112
  .amdhsa_user_sgpr_count 2
  .amdhsa_user_sgpr_kernarg_segment_ptr 1
  .amdhsa_system_sgpr_workgroup_id_x 1
  .amdhsa_float_denorm_mode_32 3
.end_amdhsa_kernel
```
